```python
import torch

def _softmax(x, axis=-1):
    return torch.softmax(x, dim=axis)
def _gelu(x):
    return torch.nn.functional.gelu(x, approximate="tanh")
def _silu(x):
    return torch.nn.functional.silu(x)
def _sigmoid(x):
    return torch.sigmoid(x)
def _layernorm(x, axis=-1, eps=1e-5):
    m = x.mean(dim=axis, keepdim=True)
    v = x.var(dim=axis, keepdim=True, unbiased=False)
    return (x - m) / torch.sqrt(v + eps)
def _scatter_add(tgt, idx, src, axis=0):
    return tgt.clone().index_add_(axis, idx, src)
def _segment_sum(src, seg, n):
    out = torch.zeros((n,) + src.shape[1:], dtype=src.dtype)
    return out.index_add_(0, seg, src)
def _pad(x, pw):
    flat = tuple(v for pair in reversed(pw) for v in pair)
    return torch.nn.functional.pad(x, flat)

kernel_name = 'gated_mix__gqa_block_cached__glu_gated_glu__decode'

def setup_inputs():

    _w = (lambda a: (lambda t: t.to(torch.bfloat16) if t.is_floating_point() else t)(torch.as_tensor(a)))
    def _A_setup():
        B, Sq, D = 2, 1, 512
        Hq, Hkv, Sk, Dh = 32, 8, 16384, 128
        assert Hq % Hkv == 0, (Hq, Hkv)
        return {
            "x": _w((lambda *s: torch.randn(*s, dtype=torch.bfloat16) * 0.05)(B, Sq, D)),
            "k_cache": _w((lambda *s: torch.randn(*s, dtype=torch.bfloat16) * 6.4)(B, Hkv, Sk, Dh)),
            "v_cache": _w((lambda *s: torch.randn(*s, dtype=torch.bfloat16) * 1.6)(B, Hkv, Sk, Dh)),
            "wq": _w((lambda *s: torch.randn(*s, dtype=torch.bfloat16) * 6.4)(D, Hq * Dh) * (D ** -0.5)),
            "wo": _w((lambda *s: torch.randn(*s, dtype=torch.bfloat16) * 1.6)(Hq * Dh, D) * ((Hq * Dh) ** -0.5)),
        }
    _A_in = _A_setup()

    def _B_setup():
        B, S, D, F = 2, 1, 512, 1792
        return {
            "x": _w((lambda *s: torch.randn(*s, dtype=torch.bfloat16) * 0.05)(B, S, D)),
            "w_gate": _w((lambda *s: torch.randn(*s, dtype=torch.bfloat16) * 1.6)(D, F)),
            "w_up": _w((lambda *s: torch.randn(*s, dtype=torch.bfloat16) * 0.05)(D, F)),
            "w_down": _w((lambda *s: torch.randn(*s, dtype=torch.bfloat16) * 0.05)(F, D)),
        }
    _B_in = _B_setup()

    return {
        "A_x": _A_in["x"],
        "A_k_cache": _A_in["k_cache"],
        "A_v_cache": _A_in["v_cache"],
        "A_wq": _A_in["wq"],
        "A_wo": _A_in["wo"],
        "B_x": _B_in["x"],
        "B_w_gate": _B_in["w_gate"],
        "B_w_up": _B_in["w_up"],
        "B_w_down": _B_in["w_down"],
        "gate_w": _w((lambda *s: torch.randn(*s, dtype=torch.bfloat16) * 0.05)(512) * 16.0),
    }

def reference(A_x, A_k_cache, A_v_cache, A_wq, A_wo, B_x, B_w_gate, B_w_up, B_w_down, gate_w):
    def _A_ref(x, k_cache, v_cache, wq, wo):
        B, Sq, D = x.shape
        Hq, Dh = 32, 128
        Hkv = k_cache.shape[1]
        rep = Hq // Hkv
        q = (lambda x, *d: x.permute(*d))((x @ wq).reshape(B, Sq, Hq, Dh), 0, 2, 1, 3)
        k = (lambda x, n, axis: torch.repeat_interleave(x, n, dim=axis))(k_cache, rep, axis=1)
        v = (lambda x, n, axis: torch.repeat_interleave(x, n, dim=axis))(v_cache, rep, axis=1)
        scores = torch.einsum("bhqd,bhkd->bhqk", q, k) * (Dh ** -0.5)
        p = _softmax(scores, axis=-1)
        o = torch.einsum("bhqk,bhkd->bhqd", p, v)
        return (lambda x, *d: x.permute(*d))(o, 0, 2, 1, 3).reshape(B, Sq, Hq * Dh) @ wo

    def _B_ref(x, w_gate, w_up, w_down):
        g = torch.einsum("bsd,df->bsf", x, w_gate)
        u = torch.einsum("bsd,df->bsf", x, w_up)
        h = _sigmoid(g) * u
        return torch.einsum("bsf,fd->bsd", h, w_down)

    x = A_x
    g = _sigmoid((x * gate_w).sum(-1, keepdims=True))
    a = _A_ref(x, A_k_cache, A_v_cache, A_wq, A_wo)
    b = _B_ref(x, B_w_gate, B_w_up, B_w_down)
    return g * a + (1 - g) * b
```

```asm
; @launch grid=(256,1,1) block=(512,1,1) lds=14336
.amdgcn_target "amdgcn-amd-amdhsa--gfx950"
.text
.globl gated_mix__gqa_block_cached__glu_gated_glu__decode_kernel
.p2align 8
.type gated_mix__gqa_block_cached__glu_gated_glu__decode_kernel,@function
gated_mix__gqa_block_cached__glu_gated_glu__decode_kernel:
    s_cmp_ge_u32 s2, 256
    s_cbranch_scc1 L_end
    s_load_dwordx16 s[36:51], s[0:1], 0
    s_load_dwordx8 s[52:59], s[0:1], 64
    s_load_dwordx2 s[60:61], s[0:1], 96
    v_lshrrev_b32 v1, 6, v0
    v_and_b32 v0, 63, v0
    v_readfirstlane_b32 s3, v1
    s_and_b32 s4, s2, 7
    s_lshr_b32 s5, s2, 3
    s_mov_b32 s11, 0x20000
    s_mov_b32 s15, 0x20000
    v_lshrrev_b32 v2, 4, v0
    s_and_b32 s32, s3, 3
    s_cmp_ge_u32 s3, 4
    s_cbranch_scc1 L_stream
    v_mov_b32 v8, 0
    v_lshlrev_b32 v1, 2, v0
    ds_write_b32 v1, v8 offset:1024
    v_and_b32 v4, 15, v0
    v_lshlrev_b32 v4, 3, v4
    v_lshl_add_u32 v3, v2, 16, v4
    s_and_b32 s26, s5, 7
    s_lshl_b32 s26, s26, 7
    s_lshl_b32 s27, s4, 10
    s_add_u32 s26, s26, s27
    v_add_u32 v3, s26, v3
    s_lshr_b32 s26, s5, 3
    s_lshl_b32 s26, s26, 2
    s_add_u32 s26, s26, s32
    s_lshl_b32 s24, s26, 18
    s_lshl_b32 s26, s26, 6
    v_bfe_u32 v1, v0, 2, 1
    v_lshlrev_b32 v9, 10, v1
    v_lshl_add_u32 v1, v2, 4, v9
    v_add_u32 v1, s26, v1
    v_mov_b32 v5, 149504
    s_mov_b32 s10, 0x400000
    s_movk_i32 s25, 0x2000
    s_waitcnt lgkmcnt(0)
    s_mov_b32 s8, s42
    s_mov_b32 s9, s43
    buffer_load_dwordx2 v[64:65], v3, s[8:11], s24 offen nt
    s_add_u32 s24, s24, s25
    buffer_load_dwordx2 v[66:67], v3, s[8:11], s24 offen nt
    s_add_u32 s24, s24, s25
    buffer_load_dwordx2 v[68:69], v3, s[8:11], s24 offen nt
    s_add_u32 s24, s24, s25
    buffer_load_dwordx2 v[70:71], v3, s[8:11], s24 offen nt
    s_add_u32 s24, s24, s25
    buffer_load_dwordx2 v[72:73], v3, s[8:11], s24 offen nt
    s_add_u32 s24, s24, s25
    buffer_load_dwordx2 v[74:75], v3, s[8:11], s24 offen nt
    s_add_u32 s24, s24, s25
    buffer_load_dwordx2 v[76:77], v3, s[8:11], s24 offen nt
    s_add_u32 s24, s24, s25
    buffer_load_dwordx2 v[78:79], v3, s[8:11], s24 offen nt
    global_load_dwordx4 v[224:227], v1, s[36:37]
    global_load_dword v7, v5, s[60:61]
    s_barrier
    s_branch L_helper
L_stream:
    s_lshr_b32 s6, s5, 4
    s_and_b32 s7, s5, 15
    s_lshl_b32 s26, s6, 3
    s_add_u32 s26, s26, s4
    s_lshl_b32 s26, s26, 4
    s_add_u32 s26, s26, s7
    s_lshl_b32 s26, s26, 8
    s_add_u32 s26, s26, s32
    s_lshl_b32 s26, s26, 10
    v_lshlrev_b32 v2, 6, v2
    v_bfe_u32 v3, v0, 2, 2
    v_lshl_add_u32 v2, v3, 8, v2
    v_and_b32 v3, 3, v0
    v_lshl_add_u32 v1, v3, 4, v2
    v_add_u32 v1, s26, v1
    s_mov_b32 s10, 0x4000000
    s_mov_b32 s24, 0
    s_movk_i32 s25, 0x1000
    s_waitcnt lgkmcnt(0)
    s_mov_b32 s8, s38
    s_mov_b32 s9, s39
    buffer_load_dwordx4 v[80:83], v1, s[8:11], s24 offen nt
    s_add_u32 s24, s24, s25
    buffer_load_dwordx4 v[84:87], v1, s[8:11], s24 offen nt
    s_add_u32 s24, s24, s25
    buffer_load_dwordx4 v[88:91], v1, s[8:11], s24 offen nt
    s_add_u32 s24, s24, s25
    buffer_load_dwordx4 v[92:95], v1, s[8:11], s24 offen nt
    s_add_u32 s24, s24, s25
    buffer_load_dwordx4 v[96:99], v1, s[8:11], s24 offen nt
    s_add_u32 s24, s24, s25
    buffer_load_dwordx4 v[100:103], v1, s[8:11], s24 offen nt
    s_add_u32 s24, s24, s25
    s_barrier
    v_lshl_add_u32 v2, v0, 4, s26
    s_mov_b32 s12, s40
    s_mov_b32 s13, s41
    s_mov_b32 s14, 0x4000000
    s_mov_b32 s29, 0x200000
    s_mov_b32 s64, 0x22222222
    s_mov_b32 s65, 0x22222222
    s_mov_b32 s66, 0x44444444
    s_mov_b32 s67, 0x44444444
    s_mov_b32 s68, 0x88888888
    s_mov_b32 s69, 0x88888888
    s_mov_b32 s88, 0x3db504f3
    s_mov_b32 s89, 0x3fb8aa3b
    s_mov_b32 s90, 0xffff0000
    s_mov_b32 s91, 0xfffffc00
    v_mov_b32 v64, 0xffff
    v_mov_b32 v65, s90
    v_cndmask_b32 v72, v64, v65, s[64:65]
    s_or_b64 s[26:27], s[66:67], s[68:69]
    v_cndmask_b32 v72, v72, 0, s[26:27]
    v_cndmask_b32 v73, 0, v64, s[66:67]
    v_cndmask_b32 v73, v73, v65, s[68:69]
    v_mov_b32 v8, 0
    v_mov_b32 v9, 0
    v_mov_b32 v10, 0
    v_mov_b32 v11, 0
    v_mov_b32 v12, 0
    v_mov_b32 v13, 0
    v_mov_b32 v14, 0
    v_mov_b32 v15, 0
    v_mov_b32 v74, 0xff800000
    v_mov_b32 v75, 0
    v_mov_b32 v76, 0
    s_mov_b64 vcc, 0
    s_waitcnt vmcnt(5)
    buffer_load_dwordx4 v[104:107], v1, s[8:11], s24 offen nt
    s_add_u32 s24, s24, s25
    s_waitcnt vmcnt(5)
    buffer_load_dwordx4 v[108:111], v1, s[8:11], s24 offen nt
    s_add_u32 s24, s24, s25
    s_waitcnt vmcnt(5)
    buffer_load_dwordx4 v[112:115], v1, s[8:11], s24 offen nt
    s_add_u32 s24, s24, s25
    s_waitcnt vmcnt(5)
    buffer_load_dwordx4 v[116:119], v1, s[8:11], s24 offen nt
    s_add_u32 s24, s24, s25
    s_waitcnt vmcnt(5)
    buffer_load_dwordx4 v[120:123], v1, s[8:11], s24 offen nt
    s_add_u32 s24, s24, s25
    s_waitcnt vmcnt(5)
    buffer_load_dwordx4 v[124:127], v1, s[8:11], s24 offen nt
    s_add_u32 s24, s24, s25
    s_waitcnt vmcnt(5)
    buffer_load_dwordx4 v[128:131], v1, s[8:11], s24 offen nt
    s_add_u32 s24, s24, s25
    s_waitcnt vmcnt(5)
    buffer_load_dwordx4 v[132:135], v1, s[8:11], s24 offen nt
    s_add_u32 s24, s24, s25
    s_waitcnt vmcnt(5)
    buffer_load_dwordx4 v[136:139], v1, s[8:11], s24 offen nt
    s_add_u32 s24, s24, s25
    s_waitcnt vmcnt(5)
    buffer_load_dwordx4 v[140:143], v1, s[8:11], s24 offen nt
    s_add_u32 s24, s24, s25
    s_waitcnt vmcnt(5)
    buffer_load_dwordx4 v[144:147], v1, s[8:11], s24 offen nt
    s_add_u32 s24, s24, s25
    s_waitcnt vmcnt(5)
    buffer_load_dwordx4 v[148:151], v1, s[8:11], s24 offen nt
    s_add_u32 s24, s24, s25
    s_waitcnt vmcnt(5)
    buffer_load_dwordx4 v[152:155], v1, s[8:11], s24 offen nt
    s_add_u32 s24, s24, s25
    s_waitcnt vmcnt(5)
    buffer_load_dwordx4 v[156:159], v1, s[8:11], s24 offen nt
    s_add_u32 s24, s24, s25
    s_waitcnt vmcnt(5)
    buffer_load_dwordx4 v[160:163], v1, s[8:11], s24 offen nt
    s_add_u32 s24, s24, s25
    s_waitcnt vmcnt(5)
    buffer_load_dwordx4 v[164:167], v1, s[8:11], s24 offen nt
    s_add_u32 s24, s24, s25
    s_waitcnt vmcnt(5)
    buffer_load_dwordx4 v[168:171], v1, s[8:11], s24 offen nt
    s_add_u32 s24, s24, s25
    s_waitcnt vmcnt(5)
    buffer_load_dwordx4 v[172:175], v1, s[8:11], s24 offen nt
    s_add_u32 s24, s24, s25
    s_waitcnt vmcnt(5)
    buffer_load_dwordx4 v[176:179], v1, s[8:11], s24 offen nt
    s_add_u32 s24, s24, s25
    s_waitcnt vmcnt(5)
    buffer_load_dwordx4 v[180:183], v1, s[8:11], s24 offen nt
    s_add_u32 s24, s24, s25
    s_waitcnt vmcnt(5)
    buffer_load_dwordx4 v[184:187], v1, s[8:11], s24 offen nt
    s_add_u32 s24, s24, s25
    s_waitcnt vmcnt(5)
    buffer_load_dwordx4 v[188:191], v1, s[8:11], s24 offen nt
    s_add_u32 s24, s24, s25
    s_waitcnt vmcnt(5)
    buffer_load_dwordx4 v[192:195], v1, s[8:11], s24 offen nt
    s_add_u32 s24, s24, s25
    s_waitcnt vmcnt(5)
    buffer_load_dwordx4 v[196:199], v1, s[8:11], s24 offen nt
    s_add_u32 s24, s24, s25
    s_waitcnt vmcnt(5)
    buffer_load_dwordx4 v[200:203], v1, s[8:11], s24 offen nt
    s_add_u32 s24, s24, s25
    s_waitcnt vmcnt(5)
    buffer_load_dwordx4 v[204:207], v1, s[8:11], s24 offen nt
    s_add_u32 s24, s24, s25
    s_waitcnt vmcnt(5)
    buffer_load_dwordx4 v[208:211], v1, s[8:11], s24 offen nt
    s_add_u32 s24, s24, s25
    s_waitcnt vmcnt(5)
    buffer_load_dwordx4 v[212:215], v1, s[8:11], s24 offen nt
    s_add_u32 s24, s24, s25
    s_waitcnt vmcnt(5)
    buffer_load_dwordx4 v[216:219], v1, s[8:11], s24 offen nt
    s_add_u32 s24, s24, s25
    s_waitcnt vmcnt(5)
    buffer_load_dwordx4 v[220:223], v1, s[8:11], s24 offen nt
    s_add_u32 s24, s24, s25
    s_waitcnt vmcnt(5)
    buffer_load_dwordx4 v[224:227], v1, s[8:11], s24 offen nt
    s_add_u32 s24, s24, s25
    s_waitcnt vmcnt(5)
    buffer_load_dwordx4 v[228:231], v1, s[8:11], s24 offen nt
    s_add_u32 s24, s24, s25
    s_waitcnt vmcnt(5)
    buffer_load_dwordx4 v[232:235], v1, s[8:11], s24 offen nt
    s_add_u32 s24, s24, s25
    s_waitcnt vmcnt(5)
    buffer_load_dwordx4 v[236:239], v1, s[8:11], s24 offen nt
    s_add_u32 s24, s24, s25
    v_lshlrev_b32 v3, 4, v0
    v_mov_b32 v64, 0
L_qw:
    ds_read_b32 v65, v64 offset:1040
    ds_read_b128 v[4:7], v3 offset:0
    s_waitcnt lgkmcnt(0)
    v_readfirstlane_b32 s94, v65
    s_nop 0
    s_cmp_lg_u32 s94, 0
    s_cbranch_scc1 L_qwd
    s_sleep 1
    s_sub_u32 s29, s29, 1
    s_cbranch_scc0 L_qw
    s_branch L_abort
L_qwd:
    s_waitcnt vmcnt(5)
    buffer_load_dwordx4 v[240:243], v1, s[8:11], s24 offen nt
    s_add_u32 s24, s24, s25
    v_mfma_f32_16x16x32_bf16 v[32:35], v[80:83], v[4:7], 0
    v_mfma_f32_16x16x32_bf16 v[36:39], v[84:87], v[4:7], 0
    v_mfma_f32_16x16x32_bf16 v[40:43], v[88:91], v[4:7], 0
    v_mfma_f32_16x16x32_bf16 v[44:47], v[92:95], v[4:7], 0
    v_mfma_f32_16x16x32_bf16 v[48:51], v[96:99], v[4:7], 0
    v_mfma_f32_16x16x32_bf16 v[52:55], v[100:103], v[4:7], 0
    v_mfma_f32_16x16x32_bf16 v[56:59], v[104:107], v[4:7], 0
    v_mfma_f32_16x16x32_bf16 v[60:63], v[108:111], v[4:7], 0
    s_nop 0
    v_mov_b32_dpp v64, v32 quad_perm:[0,0,0,0] row_mask:0xf bank_mask:0xf
    v_mov_b32_dpp v65, v36 quad_perm:[0,0,0,0] row_mask:0xf bank_mask:0xf
    v_mov_b32_dpp v66, v40 quad_perm:[0,0,0,0] row_mask:0xf bank_mask:0xf
    v_mov_b32_dpp v67, v44 quad_perm:[0,0,0,0] row_mask:0xf bank_mask:0xf
    v_add_f32_dpp v64, v33, v64 quad_perm:[1,1,1,1] row_mask:0xf bank_mask:0xf
    v_add_f32_dpp v65, v37, v65 quad_perm:[1,1,1,1] row_mask:0xf bank_mask:0xf
    v_add_f32_dpp v66, v41, v66 quad_perm:[1,1,1,1] row_mask:0xf bank_mask:0xf
    v_add_f32_dpp v67, v45, v67 quad_perm:[1,1,1,1] row_mask:0xf bank_mask:0xf
    v_add_f32_dpp v64, v34, v64 quad_perm:[2,2,2,2] row_mask:0xf bank_mask:0xf
    v_add_f32_dpp v65, v38, v65 quad_perm:[2,2,2,2] row_mask:0xf bank_mask:0xf
    v_add_f32_dpp v66, v42, v66 quad_perm:[2,2,2,2] row_mask:0xf bank_mask:0xf
    v_add_f32_dpp v67, v46, v67 quad_perm:[2,2,2,2] row_mask:0xf bank_mask:0xf
    v_add_f32_dpp v64, v35, v64 quad_perm:[3,3,3,3] row_mask:0xf bank_mask:0xf
    v_add_f32_dpp v65, v39, v65 quad_perm:[3,3,3,3] row_mask:0xf bank_mask:0xf
    v_add_f32_dpp v66, v43, v66 quad_perm:[3,3,3,3] row_mask:0xf bank_mask:0xf
    v_add_f32_dpp v67, v47, v67 quad_perm:[3,3,3,3] row_mask:0xf bank_mask:0xf
    v_cndmask_b32 v16, v64, v65, s[64:65]
    v_cndmask_b32 v16, v16, v66, s[66:67]
    v_cndmask_b32 v16, v16, v67, s[68:69]
    s_waitcnt vmcnt(5)
    buffer_load_dwordx4 v[244:247], v1, s[8:11], s24 offen nt
    s_add_u32 s24, s24, s25
    v_mfma_f32_16x16x32_bf16 v[32:35], v[112:115], v[4:7], 0
    v_mfma_f32_16x16x32_bf16 v[36:39], v[116:119], v[4:7], 0
    v_mfma_f32_16x16x32_bf16 v[40:43], v[120:123], v[4:7], 0
    v_mfma_f32_16x16x32_bf16 v[44:47], v[124:127], v[4:7], 0
    v_mov_b32_dpp v64, v48 quad_perm:[0,0,0,0] row_mask:0xf bank_mask:0xf
    v_mov_b32_dpp v65, v52 quad_perm:[0,0,0,0] row_mask:0xf bank_mask:0xf
    v_mov_b32_dpp v66, v56 quad_perm:[0,0,0,0] row_mask:0xf bank_mask:0xf
    v_mov_b32_dpp v67, v60 quad_perm:[0,0,0,0] row_mask:0xf bank_mask:0xf
    v_add_f32_dpp v64, v49, v64 quad_perm:[1,1,1,1] row_mask:0xf bank_mask:0xf
    v_add_f32_dpp v65, v53, v65 quad_perm:[1,1,1,1] row_mask:0xf bank_mask:0xf
    v_add_f32_dpp v66, v57, v66 quad_perm:[1,1,1,1] row_mask:0xf bank_mask:0xf
    v_add_f32_dpp v67, v61, v67 quad_perm:[1,1,1,1] row_mask:0xf bank_mask:0xf
    v_add_f32_dpp v64, v50, v64 quad_perm:[2,2,2,2] row_mask:0xf bank_mask:0xf
    v_add_f32_dpp v65, v54, v65 quad_perm:[2,2,2,2] row_mask:0xf bank_mask:0xf
    v_add_f32_dpp v66, v58, v66 quad_perm:[2,2,2,2] row_mask:0xf bank_mask:0xf
    v_add_f32_dpp v67, v62, v67 quad_perm:[2,2,2,2] row_mask:0xf bank_mask:0xf
    v_add_f32_dpp v64, v51, v64 quad_perm:[3,3,3,3] row_mask:0xf bank_mask:0xf
    v_add_f32_dpp v65, v55, v65 quad_perm:[3,3,3,3] row_mask:0xf bank_mask:0xf
    v_add_f32_dpp v66, v59, v66 quad_perm:[3,3,3,3] row_mask:0xf bank_mask:0xf
    v_add_f32_dpp v67, v63, v67 quad_perm:[3,3,3,3] row_mask:0xf bank_mask:0xf
    v_cndmask_b32 v17, v64, v65, s[64:65]
    v_cndmask_b32 v17, v17, v66, s[66:67]
    v_cndmask_b32 v17, v17, v67, s[68:69]
    v_cvt_pk_bf16_f32 v64, v16, v17
    v_lshlrev_b32 v16, 16, v64
    v_and_b32 v17, s90, v64
    v_mul_f32 v16, s88, v16
    v_mul_f32 v17, s88, v17
    v_cvt_pk_bf16_f32 v64, v16, v17
    v_lshlrev_b32 v16, 16, v64
    v_and_b32 v17, s90, v64
    v_max3_f32 v74, v74, v16, v17
    v_mfma_f32_16x16x32_bf16 v[48:51], v[128:131], v[4:7], 0
    v_mfma_f32_16x16x32_bf16 v[52:55], v[132:135], v[4:7], 0
    v_mfma_f32_16x16x32_bf16 v[56:59], v[136:139], v[4:7], 0
    v_mfma_f32_16x16x32_bf16 v[60:63], v[140:143], v[4:7], 0
    v_mov_b32_dpp v64, v32 quad_perm:[0,0,0,0] row_mask:0xf bank_mask:0xf
    v_mov_b32_dpp v65, v36 quad_perm:[0,0,0,0] row_mask:0xf bank_mask:0xf
    v_mov_b32_dpp v66, v40 quad_perm:[0,0,0,0] row_mask:0xf bank_mask:0xf
    v_mov_b32_dpp v67, v44 quad_perm:[0,0,0,0] row_mask:0xf bank_mask:0xf
    v_add_f32_dpp v64, v33, v64 quad_perm:[1,1,1,1] row_mask:0xf bank_mask:0xf
    v_add_f32_dpp v65, v37, v65 quad_perm:[1,1,1,1] row_mask:0xf bank_mask:0xf
    v_add_f32_dpp v66, v41, v66 quad_perm:[1,1,1,1] row_mask:0xf bank_mask:0xf
    v_add_f32_dpp v67, v45, v67 quad_perm:[1,1,1,1] row_mask:0xf bank_mask:0xf
    v_add_f32_dpp v64, v34, v64 quad_perm:[2,2,2,2] row_mask:0xf bank_mask:0xf
    v_add_f32_dpp v65, v38, v65 quad_perm:[2,2,2,2] row_mask:0xf bank_mask:0xf
    v_add_f32_dpp v66, v42, v66 quad_perm:[2,2,2,2] row_mask:0xf bank_mask:0xf
    v_add_f32_dpp v67, v46, v67 quad_perm:[2,2,2,2] row_mask:0xf bank_mask:0xf
    v_add_f32_dpp v64, v35, v64 quad_perm:[3,3,3,3] row_mask:0xf bank_mask:0xf
    v_add_f32_dpp v65, v39, v65 quad_perm:[3,3,3,3] row_mask:0xf bank_mask:0xf
    v_add_f32_dpp v66, v43, v66 quad_perm:[3,3,3,3] row_mask:0xf bank_mask:0xf
    v_add_f32_dpp v67, v47, v67 quad_perm:[3,3,3,3] row_mask:0xf bank_mask:0xf
    v_cndmask_b32 v18, v64, v65, s[64:65]
    v_cndmask_b32 v18, v18, v66, s[66:67]
    v_cndmask_b32 v18, v18, v67, s[68:69]
    s_waitcnt vmcnt(5)
    buffer_load_dwordx4 v[248:251], v1, s[8:11], s24 offen nt
    s_add_u32 s24, s24, s25
    v_mfma_f32_16x16x32_bf16 v[32:35], v[144:147], v[4:7], 0
    v_mfma_f32_16x16x32_bf16 v[36:39], v[148:151], v[4:7], 0
    v_mfma_f32_16x16x32_bf16 v[40:43], v[152:155], v[4:7], 0
    v_mfma_f32_16x16x32_bf16 v[44:47], v[156:159], v[4:7], 0
    v_mov_b32_dpp v64, v48 quad_perm:[0,0,0,0] row_mask:0xf bank_mask:0xf
    v_mov_b32_dpp v65, v52 quad_perm:[0,0,0,0] row_mask:0xf bank_mask:0xf
    v_mov_b32_dpp v66, v56 quad_perm:[0,0,0,0] row_mask:0xf bank_mask:0xf
    v_mov_b32_dpp v67, v60 quad_perm:[0,0,0,0] row_mask:0xf bank_mask:0xf
    v_add_f32_dpp v64, v49, v64 quad_perm:[1,1,1,1] row_mask:0xf bank_mask:0xf
    v_add_f32_dpp v65, v53, v65 quad_perm:[1,1,1,1] row_mask:0xf bank_mask:0xf
    v_add_f32_dpp v66, v57, v66 quad_perm:[1,1,1,1] row_mask:0xf bank_mask:0xf
    v_add_f32_dpp v67, v61, v67 quad_perm:[1,1,1,1] row_mask:0xf bank_mask:0xf
    v_add_f32_dpp v64, v50, v64 quad_perm:[2,2,2,2] row_mask:0xf bank_mask:0xf
    v_add_f32_dpp v65, v54, v65 quad_perm:[2,2,2,2] row_mask:0xf bank_mask:0xf
    v_add_f32_dpp v66, v58, v66 quad_perm:[2,2,2,2] row_mask:0xf bank_mask:0xf
    v_add_f32_dpp v67, v62, v67 quad_perm:[2,2,2,2] row_mask:0xf bank_mask:0xf
    v_add_f32_dpp v64, v51, v64 quad_perm:[3,3,3,3] row_mask:0xf bank_mask:0xf
    v_add_f32_dpp v65, v55, v65 quad_perm:[3,3,3,3] row_mask:0xf bank_mask:0xf
    v_add_f32_dpp v66, v59, v66 quad_perm:[3,3,3,3] row_mask:0xf bank_mask:0xf
    v_add_f32_dpp v67, v63, v67 quad_perm:[3,3,3,3] row_mask:0xf bank_mask:0xf
    v_cndmask_b32 v19, v64, v65, s[64:65]
    v_cndmask_b32 v19, v19, v66, s[66:67]
    v_cndmask_b32 v19, v19, v67, s[68:69]
    v_cvt_pk_bf16_f32 v64, v18, v19
    v_lshlrev_b32 v18, 16, v64
    v_and_b32 v19, s90, v64
    v_mul_f32 v18, s88, v18
    v_mul_f32 v19, s88, v19
    v_cvt_pk_bf16_f32 v64, v18, v19
    v_lshlrev_b32 v18, 16, v64
    v_and_b32 v19, s90, v64
    v_max3_f32 v74, v74, v18, v19
    v_mfma_f32_16x16x32_bf16 v[48:51], v[160:163], v[4:7], 0
    v_mfma_f32_16x16x32_bf16 v[52:55], v[164:167], v[4:7], 0
    v_mfma_f32_16x16x32_bf16 v[56:59], v[168:171], v[4:7], 0
    v_mfma_f32_16x16x32_bf16 v[60:63], v[172:175], v[4:7], 0
    v_mov_b32_dpp v64, v32 quad_perm:[0,0,0,0] row_mask:0xf bank_mask:0xf
    v_mov_b32_dpp v65, v36 quad_perm:[0,0,0,0] row_mask:0xf bank_mask:0xf
    v_mov_b32_dpp v66, v40 quad_perm:[0,0,0,0] row_mask:0xf bank_mask:0xf
    v_mov_b32_dpp v67, v44 quad_perm:[0,0,0,0] row_mask:0xf bank_mask:0xf
    v_add_f32_dpp v64, v33, v64 quad_perm:[1,1,1,1] row_mask:0xf bank_mask:0xf
    v_add_f32_dpp v65, v37, v65 quad_perm:[1,1,1,1] row_mask:0xf bank_mask:0xf
    v_add_f32_dpp v66, v41, v66 quad_perm:[1,1,1,1] row_mask:0xf bank_mask:0xf
    v_add_f32_dpp v67, v45, v67 quad_perm:[1,1,1,1] row_mask:0xf bank_mask:0xf
    v_add_f32_dpp v64, v34, v64 quad_perm:[2,2,2,2] row_mask:0xf bank_mask:0xf
    v_add_f32_dpp v65, v38, v65 quad_perm:[2,2,2,2] row_mask:0xf bank_mask:0xf
    v_add_f32_dpp v66, v42, v66 quad_perm:[2,2,2,2] row_mask:0xf bank_mask:0xf
    v_add_f32_dpp v67, v46, v67 quad_perm:[2,2,2,2] row_mask:0xf bank_mask:0xf
    v_add_f32_dpp v64, v35, v64 quad_perm:[3,3,3,3] row_mask:0xf bank_mask:0xf
    v_add_f32_dpp v65, v39, v65 quad_perm:[3,3,3,3] row_mask:0xf bank_mask:0xf
    v_add_f32_dpp v66, v43, v66 quad_perm:[3,3,3,3] row_mask:0xf bank_mask:0xf
    v_add_f32_dpp v67, v47, v67 quad_perm:[3,3,3,3] row_mask:0xf bank_mask:0xf
    v_cndmask_b32 v20, v64, v65, s[64:65]
    v_cndmask_b32 v20, v20, v66, s[66:67]
    v_cndmask_b32 v20, v20, v67, s[68:69]
    s_waitcnt vmcnt(5)
    buffer_load_dwordx4 v[252:255], v1, s[8:11], s24 offen nt
    s_add_u32 s24, s24, s25
    v_mfma_f32_16x16x32_bf16 v[32:35], v[176:179], v[4:7], 0
    v_mfma_f32_16x16x32_bf16 v[36:39], v[180:183], v[4:7], 0
    v_mfma_f32_16x16x32_bf16 v[40:43], v[184:187], v[4:7], 0
    v_mfma_f32_16x16x32_bf16 v[44:47], v[188:191], v[4:7], 0
    v_mov_b32_dpp v64, v48 quad_perm:[0,0,0,0] row_mask:0xf bank_mask:0xf
    v_mov_b32_dpp v65, v52 quad_perm:[0,0,0,0] row_mask:0xf bank_mask:0xf
    v_mov_b32_dpp v66, v56 quad_perm:[0,0,0,0] row_mask:0xf bank_mask:0xf
    v_mov_b32_dpp v67, v60 quad_perm:[0,0,0,0] row_mask:0xf bank_mask:0xf
    v_add_f32_dpp v64, v49, v64 quad_perm:[1,1,1,1] row_mask:0xf bank_mask:0xf
    v_add_f32_dpp v65, v53, v65 quad_perm:[1,1,1,1] row_mask:0xf bank_mask:0xf
    v_add_f32_dpp v66, v57, v66 quad_perm:[1,1,1,1] row_mask:0xf bank_mask:0xf
    v_add_f32_dpp v67, v61, v67 quad_perm:[1,1,1,1] row_mask:0xf bank_mask:0xf
    v_add_f32_dpp v64, v50, v64 quad_perm:[2,2,2,2] row_mask:0xf bank_mask:0xf
    v_add_f32_dpp v65, v54, v65 quad_perm:[2,2,2,2] row_mask:0xf bank_mask:0xf
    v_add_f32_dpp v66, v58, v66 quad_perm:[2,2,2,2] row_mask:0xf bank_mask:0xf
    v_add_f32_dpp v67, v62, v67 quad_perm:[2,2,2,2] row_mask:0xf bank_mask:0xf
    v_add_f32_dpp v64, v51, v64 quad_perm:[3,3,3,3] row_mask:0xf bank_mask:0xf
    v_add_f32_dpp v65, v55, v65 quad_perm:[3,3,3,3] row_mask:0xf bank_mask:0xf
    v_add_f32_dpp v66, v59, v66 quad_perm:[3,3,3,3] row_mask:0xf bank_mask:0xf
    v_add_f32_dpp v67, v63, v67 quad_perm:[3,3,3,3] row_mask:0xf bank_mask:0xf
    v_cndmask_b32 v21, v64, v65, s[64:65]
    v_cndmask_b32 v21, v21, v66, s[66:67]
    v_cndmask_b32 v21, v21, v67, s[68:69]
    v_cvt_pk_bf16_f32 v64, v20, v21
    v_lshlrev_b32 v20, 16, v64
    v_and_b32 v21, s90, v64
    v_mul_f32 v20, s88, v20
    v_mul_f32 v21, s88, v21
    v_cvt_pk_bf16_f32 v64, v20, v21
    v_lshlrev_b32 v20, 16, v64
    v_and_b32 v21, s90, v64
    v_max3_f32 v74, v74, v20, v21
    v_mfma_f32_16x16x32_bf16 v[48:51], v[192:195], v[4:7], 0
    v_mfma_f32_16x16x32_bf16 v[52:55], v[196:199], v[4:7], 0
    v_mfma_f32_16x16x32_bf16 v[56:59], v[200:203], v[4:7], 0
    v_mfma_f32_16x16x32_bf16 v[60:63], v[204:207], v[4:7], 0
    v_mov_b32_dpp v64, v32 quad_perm:[0,0,0,0] row_mask:0xf bank_mask:0xf
    v_mov_b32_dpp v65, v36 quad_perm:[0,0,0,0] row_mask:0xf bank_mask:0xf
    v_mov_b32_dpp v66, v40 quad_perm:[0,0,0,0] row_mask:0xf bank_mask:0xf
    v_mov_b32_dpp v67, v44 quad_perm:[0,0,0,0] row_mask:0xf bank_mask:0xf
    v_add_f32_dpp v64, v33, v64 quad_perm:[1,1,1,1] row_mask:0xf bank_mask:0xf
    v_add_f32_dpp v65, v37, v65 quad_perm:[1,1,1,1] row_mask:0xf bank_mask:0xf
    v_add_f32_dpp v66, v41, v66 quad_perm:[1,1,1,1] row_mask:0xf bank_mask:0xf
    v_add_f32_dpp v67, v45, v67 quad_perm:[1,1,1,1] row_mask:0xf bank_mask:0xf
    v_add_f32_dpp v64, v34, v64 quad_perm:[2,2,2,2] row_mask:0xf bank_mask:0xf
    v_add_f32_dpp v65, v38, v65 quad_perm:[2,2,2,2] row_mask:0xf bank_mask:0xf
    v_add_f32_dpp v66, v42, v66 quad_perm:[2,2,2,2] row_mask:0xf bank_mask:0xf
    v_add_f32_dpp v67, v46, v67 quad_perm:[2,2,2,2] row_mask:0xf bank_mask:0xf
    v_add_f32_dpp v64, v35, v64 quad_perm:[3,3,3,3] row_mask:0xf bank_mask:0xf
    v_add_f32_dpp v65, v39, v65 quad_perm:[3,3,3,3] row_mask:0xf bank_mask:0xf
    v_add_f32_dpp v66, v43, v66 quad_perm:[3,3,3,3] row_mask:0xf bank_mask:0xf
    v_add_f32_dpp v67, v47, v67 quad_perm:[3,3,3,3] row_mask:0xf bank_mask:0xf
    v_cndmask_b32 v22, v64, v65, s[64:65]
    v_cndmask_b32 v22, v22, v66, s[66:67]
    v_cndmask_b32 v22, v22, v67, s[68:69]
    s_waitcnt vmcnt(5)
    buffer_load_dwordx4 v[80:83], v1, s[8:11], s24 offen nt
    s_add_u32 s24, s24, s25
    v_mfma_f32_16x16x32_bf16 v[32:35], v[208:211], v[4:7], 0
    v_mfma_f32_16x16x32_bf16 v[36:39], v[212:215], v[4:7], 0
    v_mfma_f32_16x16x32_bf16 v[40:43], v[216:219], v[4:7], 0
    v_mfma_f32_16x16x32_bf16 v[44:47], v[220:223], v[4:7], 0
    v_mov_b32_dpp v64, v48 quad_perm:[0,0,0,0] row_mask:0xf bank_mask:0xf
    v_mov_b32_dpp v65, v52 quad_perm:[0,0,0,0] row_mask:0xf bank_mask:0xf
    v_mov_b32_dpp v66, v56 quad_perm:[0,0,0,0] row_mask:0xf bank_mask:0xf
    v_mov_b32_dpp v67, v60 quad_perm:[0,0,0,0] row_mask:0xf bank_mask:0xf
    v_add_f32_dpp v64, v49, v64 quad_perm:[1,1,1,1] row_mask:0xf bank_mask:0xf
    v_add_f32_dpp v65, v53, v65 quad_perm:[1,1,1,1] row_mask:0xf bank_mask:0xf
    v_add_f32_dpp v66, v57, v66 quad_perm:[1,1,1,1] row_mask:0xf bank_mask:0xf
    v_add_f32_dpp v67, v61, v67 quad_perm:[1,1,1,1] row_mask:0xf bank_mask:0xf
    v_add_f32_dpp v64, v50, v64 quad_perm:[2,2,2,2] row_mask:0xf bank_mask:0xf
    v_add_f32_dpp v65, v54, v65 quad_perm:[2,2,2,2] row_mask:0xf bank_mask:0xf
    v_add_f32_dpp v66, v58, v66 quad_perm:[2,2,2,2] row_mask:0xf bank_mask:0xf
    v_add_f32_dpp v67, v62, v67 quad_perm:[2,2,2,2] row_mask:0xf bank_mask:0xf
    v_add_f32_dpp v64, v51, v64 quad_perm:[3,3,3,3] row_mask:0xf bank_mask:0xf
    v_add_f32_dpp v65, v55, v65 quad_perm:[3,3,3,3] row_mask:0xf bank_mask:0xf
    v_add_f32_dpp v66, v59, v66 quad_perm:[3,3,3,3] row_mask:0xf bank_mask:0xf
    v_add_f32_dpp v67, v63, v67 quad_perm:[3,3,3,3] row_mask:0xf bank_mask:0xf
    v_cndmask_b32 v23, v64, v65, s[64:65]
    v_cndmask_b32 v23, v23, v66, s[66:67]
    v_cndmask_b32 v23, v23, v67, s[68:69]
    v_cvt_pk_bf16_f32 v64, v22, v23
    v_lshlrev_b32 v22, 16, v64
    v_and_b32 v23, s90, v64
    v_mul_f32 v22, s88, v22
    v_mul_f32 v23, s88, v23
    v_cvt_pk_bf16_f32 v64, v22, v23
    v_lshlrev_b32 v22, 16, v64
    v_and_b32 v23, s90, v64
    v_max3_f32 v74, v74, v22, v23
    s_waitcnt vmcnt(5)
    buffer_load_dwordx4 v[84:87], v1, s[8:11], s24 offen nt
    s_add_u32 s24, s24, s25
    v_mfma_f32_16x16x32_bf16 v[48:51], v[224:227], v[4:7], 0
    v_mfma_f32_16x16x32_bf16 v[52:55], v[228:231], v[4:7], 0
    v_mfma_f32_16x16x32_bf16 v[56:59], v[232:235], v[4:7], 0
    v_mfma_f32_16x16x32_bf16 v[60:63], v[236:239], v[4:7], 0
    v_mov_b32_dpp v64, v32 quad_perm:[0,0,0,0] row_mask:0xf bank_mask:0xf
    v_mov_b32_dpp v65, v36 quad_perm:[0,0,0,0] row_mask:0xf bank_mask:0xf
    v_mov_b32_dpp v66, v40 quad_perm:[0,0,0,0] row_mask:0xf bank_mask:0xf
    v_mov_b32_dpp v67, v44 quad_perm:[0,0,0,0] row_mask:0xf bank_mask:0xf
    v_add_f32_dpp v64, v33, v64 quad_perm:[1,1,1,1] row_mask:0xf bank_mask:0xf
    v_add_f32_dpp v65, v37, v65 quad_perm:[1,1,1,1] row_mask:0xf bank_mask:0xf
    v_add_f32_dpp v66, v41, v66 quad_perm:[1,1,1,1] row_mask:0xf bank_mask:0xf
    v_add_f32_dpp v67, v45, v67 quad_perm:[1,1,1,1] row_mask:0xf bank_mask:0xf
    v_add_f32_dpp v64, v34, v64 quad_perm:[2,2,2,2] row_mask:0xf bank_mask:0xf
    v_add_f32_dpp v65, v38, v65 quad_perm:[2,2,2,2] row_mask:0xf bank_mask:0xf
    v_add_f32_dpp v66, v42, v66 quad_perm:[2,2,2,2] row_mask:0xf bank_mask:0xf
    v_add_f32_dpp v67, v46, v67 quad_perm:[2,2,2,2] row_mask:0xf bank_mask:0xf
    v_add_f32_dpp v64, v35, v64 quad_perm:[3,3,3,3] row_mask:0xf bank_mask:0xf
    v_add_f32_dpp v65, v39, v65 quad_perm:[3,3,3,3] row_mask:0xf bank_mask:0xf
    v_add_f32_dpp v66, v43, v66 quad_perm:[3,3,3,3] row_mask:0xf bank_mask:0xf
    v_add_f32_dpp v67, v47, v67 quad_perm:[3,3,3,3] row_mask:0xf bank_mask:0xf
    v_cndmask_b32 v24, v64, v65, s[64:65]
    v_cndmask_b32 v24, v24, v66, s[66:67]
    v_cndmask_b32 v24, v24, v67, s[68:69]
    s_waitcnt vmcnt(5)
    buffer_load_dwordx4 v[88:91], v1, s[8:11], s24 offen nt
    s_add_u32 s24, s24, s25
    s_waitcnt vmcnt(5)
    buffer_load_dwordx4 v[92:95], v1, s[8:11], s24 offen nt
    s_add_u32 s24, s24, s25
    s_waitcnt vmcnt(5)
    buffer_load_dwordx4 v[96:99], v1, s[8:11], s24 offen nt
    s_add_u32 s24, s24, s25
    v_mov_b32 v77, 48
    ds_write_b32 v76, v77 offset:1032
    ds_read_b32 v78, v76 offset:1060
    s_cbranch_vccnz L_dp1
    s_waitcnt vmcnt(5)
L_dp1:
    buffer_load_dwordx4 v[100:103], v1, s[8:11], s24 offen nt
    s_add_u32 s24, s24, s25
    s_cbranch_vccnz L_dp2
    s_waitcnt vmcnt(5)
L_dp2:
    buffer_load_dwordx4 v[104:107], v1, s[8:11], s24 offen nt
    s_add_u32 s24, s24, s25
    v_mov_b32 v77, 50
    ds_write_b32 v76, v77 offset:1032
    s_waitcnt lgkmcnt(1)
    v_cmp_ne_u32 vcc, 0, v78
    ds_read_b32 v78, v76 offset:1060
    s_cbranch_vccnz L_dp3
    s_waitcnt vmcnt(5)
L_dp3:
    s_waitcnt vmcnt(7)
    buffer_load_dwordx4 v[108:111], v1, s[8:11], s24 offen nt
    s_add_u32 s24, s24, s25
    v_mfma_f32_16x16x32_bf16 v[32:35], v[240:243], v[4:7], 0
    v_mfma_f32_16x16x32_bf16 v[36:39], v[244:247], v[4:7], 0
    v_mfma_f32_16x16x32_bf16 v[40:43], v[248:251], v[4:7], 0
    v_mfma_f32_16x16x32_bf16 v[44:47], v[252:255], v[4:7], 0
    v_mov_b32_dpp v64, v48 quad_perm:[0,0,0,0] row_mask:0xf bank_mask:0xf
    v_mov_b32_dpp v65, v52 quad_perm:[0,0,0,0] row_mask:0xf bank_mask:0xf
    v_mov_b32_dpp v66, v56 quad_perm:[0,0,0,0] row_mask:0xf bank_mask:0xf
    v_mov_b32_dpp v67, v60 quad_perm:[0,0,0,0] row_mask:0xf bank_mask:0xf
    v_add_f32_dpp v64, v49, v64 quad_perm:[1,1,1,1] row_mask:0xf bank_mask:0xf
    v_add_f32_dpp v65, v53, v65 quad_perm:[1,1,1,1] row_mask:0xf bank_mask:0xf
    v_add_f32_dpp v66, v57, v66 quad_perm:[1,1,1,1] row_mask:0xf bank_mask:0xf
    v_add_f32_dpp v67, v61, v67 quad_perm:[1,1,1,1] row_mask:0xf bank_mask:0xf
    v_add_f32_dpp v64, v50, v64 quad_perm:[2,2,2,2] row_mask:0xf bank_mask:0xf
    v_add_f32_dpp v65, v54, v65 quad_perm:[2,2,2,2] row_mask:0xf bank_mask:0xf
    v_add_f32_dpp v66, v58, v66 quad_perm:[2,2,2,2] row_mask:0xf bank_mask:0xf
    v_add_f32_dpp v67, v62, v67 quad_perm:[2,2,2,2] row_mask:0xf bank_mask:0xf
    v_add_f32_dpp v64, v51, v64 quad_perm:[3,3,3,3] row_mask:0xf bank_mask:0xf
    v_add_f32_dpp v65, v55, v65 quad_perm:[3,3,3,3] row_mask:0xf bank_mask:0xf
    v_add_f32_dpp v66, v59, v66 quad_perm:[3,3,3,3] row_mask:0xf bank_mask:0xf
    v_add_f32_dpp v67, v63, v67 quad_perm:[3,3,3,3] row_mask:0xf bank_mask:0xf
    v_cndmask_b32 v25, v64, v65, s[64:65]
    v_cndmask_b32 v25, v25, v66, s[66:67]
    v_cndmask_b32 v25, v25, v67, s[68:69]
    v_cvt_pk_bf16_f32 v64, v24, v25
    v_lshlrev_b32 v24, 16, v64
    v_and_b32 v25, s90, v64
    v_mul_f32 v24, s88, v24
    v_mul_f32 v25, s88, v25
    v_cvt_pk_bf16_f32 v64, v24, v25
    v_lshlrev_b32 v24, 16, v64
    v_and_b32 v25, s90, v64
    v_max3_f32 v74, v74, v24, v25
    s_cbranch_vccnz L_dp4
    s_waitcnt vmcnt(5)
L_dp4:
    s_waitcnt vmcnt(7)
    buffer_load_dwordx4 v[112:115], v1, s[8:11], s24 offen nt
    s_add_u32 s24, s24, s25
    v_mov_b32 v77, 52
    ds_write_b32 v76, v77 offset:1032
    s_waitcnt lgkmcnt(1)
    v_cmp_ne_u32 vcc, 0, v78
    ds_read_b32 v78, v76 offset:1060
    s_cbranch_vccnz L_dp5
    s_waitcnt vmcnt(5)
L_dp5:
    s_waitcnt vmcnt(7)
    buffer_load_dwordx4 v[116:119], v1, s[8:11], s24 offen nt
    s_add_u32 s24, s24, s25
    s_cbranch_vccnz L_dp6
    s_waitcnt vmcnt(5)
L_dp6:
    s_waitcnt vmcnt(7)
    buffer_load_dwordx4 v[120:123], v1, s[8:11], s24 offen nt
    s_add_u32 s24, s24, s25
    v_mov_b32 v77, 54
    ds_write_b32 v76, v77 offset:1032
    s_waitcnt lgkmcnt(1)
    v_cmp_ne_u32 vcc, 0, v78
    ds_read_b32 v78, v76 offset:1060
    s_cbranch_vccnz L_dp7
    s_waitcnt vmcnt(5)
L_dp7:
    s_waitcnt vmcnt(7)
    buffer_load_dwordx4 v[124:127], v1, s[8:11], s24 offen nt
    s_add_u32 s24, s24, s25
    v_mfma_f32_16x16x32_bf16 v[48:51], v[80:83], v[4:7], 0
    v_mfma_f32_16x16x32_bf16 v[52:55], v[84:87], v[4:7], 0
    v_mfma_f32_16x16x32_bf16 v[56:59], v[88:91], v[4:7], 0
    v_mfma_f32_16x16x32_bf16 v[60:63], v[92:95], v[4:7], 0
    v_mov_b32_dpp v64, v32 quad_perm:[0,0,0,0] row_mask:0xf bank_mask:0xf
    v_mov_b32_dpp v65, v36 quad_perm:[0,0,0,0] row_mask:0xf bank_mask:0xf
    v_mov_b32_dpp v66, v40 quad_perm:[0,0,0,0] row_mask:0xf bank_mask:0xf
    v_mov_b32_dpp v67, v44 quad_perm:[0,0,0,0] row_mask:0xf bank_mask:0xf
    v_add_f32_dpp v64, v33, v64 quad_perm:[1,1,1,1] row_mask:0xf bank_mask:0xf
    v_add_f32_dpp v65, v37, v65 quad_perm:[1,1,1,1] row_mask:0xf bank_mask:0xf
    v_add_f32_dpp v66, v41, v66 quad_perm:[1,1,1,1] row_mask:0xf bank_mask:0xf
    v_add_f32_dpp v67, v45, v67 quad_perm:[1,1,1,1] row_mask:0xf bank_mask:0xf
    v_add_f32_dpp v64, v34, v64 quad_perm:[2,2,2,2] row_mask:0xf bank_mask:0xf
    v_add_f32_dpp v65, v38, v65 quad_perm:[2,2,2,2] row_mask:0xf bank_mask:0xf
    v_add_f32_dpp v66, v42, v66 quad_perm:[2,2,2,2] row_mask:0xf bank_mask:0xf
    v_add_f32_dpp v67, v46, v67 quad_perm:[2,2,2,2] row_mask:0xf bank_mask:0xf
    v_add_f32_dpp v64, v35, v64 quad_perm:[3,3,3,3] row_mask:0xf bank_mask:0xf
    v_add_f32_dpp v65, v39, v65 quad_perm:[3,3,3,3] row_mask:0xf bank_mask:0xf
    v_add_f32_dpp v66, v43, v66 quad_perm:[3,3,3,3] row_mask:0xf bank_mask:0xf
    v_add_f32_dpp v67, v47, v67 quad_perm:[3,3,3,3] row_mask:0xf bank_mask:0xf
    v_cndmask_b32 v26, v64, v65, s[64:65]
    v_cndmask_b32 v26, v26, v66, s[66:67]
    v_cndmask_b32 v26, v26, v67, s[68:69]
    s_cbranch_vccnz L_dp8
    s_waitcnt vmcnt(5)
L_dp8:
    s_waitcnt vmcnt(7)
    buffer_load_dwordx4 v[128:131], v1, s[8:11], s24 offen nt
    s_add_u32 s24, s24, s25
    v_mov_b32 v77, 56
    ds_write_b32 v76, v77 offset:1032
    s_waitcnt lgkmcnt(1)
    v_cmp_ne_u32 vcc, 0, v78
    ds_read_b32 v78, v76 offset:1060
    s_cbranch_vccnz L_dp9
    s_waitcnt vmcnt(5)
L_dp9:
    s_waitcnt vmcnt(7)
    buffer_load_dwordx4 v[132:135], v1, s[8:11], s24 offen nt
    s_add_u32 s24, s24, s25
    s_cbranch_vccnz L_dp10
    s_waitcnt vmcnt(5)
L_dp10:
    s_waitcnt vmcnt(7)
    buffer_load_dwordx4 v[136:139], v1, s[8:11], s24 offen nt
    s_add_u32 s24, s24, s25
    v_mov_b32 v77, 58
    ds_write_b32 v76, v77 offset:1032
    s_waitcnt lgkmcnt(1)
    v_cmp_ne_u32 vcc, 0, v78
    ds_read_b32 v78, v76 offset:1060
    s_cbranch_vccnz L_dp11
    s_waitcnt vmcnt(5)
L_dp11:
    s_waitcnt vmcnt(7)
    buffer_load_dwordx4 v[140:143], v1, s[8:11], s24 offen nt
    s_add_u32 s24, s24, s25
    v_mfma_f32_16x16x32_bf16 v[32:35], v[96:99], v[4:7], 0
    v_mfma_f32_16x16x32_bf16 v[36:39], v[100:103], v[4:7], 0
    v_mfma_f32_16x16x32_bf16 v[40:43], v[104:107], v[4:7], 0
    v_mfma_f32_16x16x32_bf16 v[44:47], v[108:111], v[4:7], 0
    v_mov_b32_dpp v64, v48 quad_perm:[0,0,0,0] row_mask:0xf bank_mask:0xf
    v_mov_b32_dpp v65, v52 quad_perm:[0,0,0,0] row_mask:0xf bank_mask:0xf
    v_mov_b32_dpp v66, v56 quad_perm:[0,0,0,0] row_mask:0xf bank_mask:0xf
    v_mov_b32_dpp v67, v60 quad_perm:[0,0,0,0] row_mask:0xf bank_mask:0xf
    v_add_f32_dpp v64, v49, v64 quad_perm:[1,1,1,1] row_mask:0xf bank_mask:0xf
    v_add_f32_dpp v65, v53, v65 quad_perm:[1,1,1,1] row_mask:0xf bank_mask:0xf
    v_add_f32_dpp v66, v57, v66 quad_perm:[1,1,1,1] row_mask:0xf bank_mask:0xf
    v_add_f32_dpp v67, v61, v67 quad_perm:[1,1,1,1] row_mask:0xf bank_mask:0xf
    v_add_f32_dpp v64, v50, v64 quad_perm:[2,2,2,2] row_mask:0xf bank_mask:0xf
    v_add_f32_dpp v65, v54, v65 quad_perm:[2,2,2,2] row_mask:0xf bank_mask:0xf
    v_add_f32_dpp v66, v58, v66 quad_perm:[2,2,2,2] row_mask:0xf bank_mask:0xf
    v_add_f32_dpp v67, v62, v67 quad_perm:[2,2,2,2] row_mask:0xf bank_mask:0xf
    v_add_f32_dpp v64, v51, v64 quad_perm:[3,3,3,3] row_mask:0xf bank_mask:0xf
    v_add_f32_dpp v65, v55, v65 quad_perm:[3,3,3,3] row_mask:0xf bank_mask:0xf
    v_add_f32_dpp v66, v59, v66 quad_perm:[3,3,3,3] row_mask:0xf bank_mask:0xf
    v_add_f32_dpp v67, v63, v67 quad_perm:[3,3,3,3] row_mask:0xf bank_mask:0xf
    v_cndmask_b32 v27, v64, v65, s[64:65]
    v_cndmask_b32 v27, v27, v66, s[66:67]
    v_cndmask_b32 v27, v27, v67, s[68:69]
    v_cvt_pk_bf16_f32 v64, v26, v27
    v_lshlrev_b32 v26, 16, v64
    v_and_b32 v27, s90, v64
    v_mul_f32 v26, s88, v26
    v_mul_f32 v27, s88, v27
    v_cvt_pk_bf16_f32 v64, v26, v27
    v_lshlrev_b32 v26, 16, v64
    v_and_b32 v27, s90, v64
    v_max3_f32 v74, v74, v26, v27
    s_cbranch_vccnz L_dp12
    s_waitcnt vmcnt(5)
L_dp12:
    s_waitcnt vmcnt(7)
    buffer_load_dwordx4 v[144:147], v1, s[8:11], s24 offen nt
    s_add_u32 s24, s24, s25
    v_mov_b32 v77, 60
    ds_write_b32 v76, v77 offset:1032
    s_waitcnt lgkmcnt(1)
    v_cmp_ne_u32 vcc, 0, v78
    ds_read_b32 v78, v76 offset:1060
    s_cbranch_vccnz L_dp13
    s_waitcnt vmcnt(5)
L_dp13:
    s_waitcnt vmcnt(7)
    buffer_load_dwordx4 v[148:151], v1, s[8:11], s24 offen nt
    s_add_u32 s24, s24, s25
    s_cbranch_vccnz L_dp14
    s_waitcnt vmcnt(5)
L_dp14:
    s_waitcnt vmcnt(7)
    buffer_load_dwordx4 v[152:155], v1, s[8:11], s24 offen nt
    s_add_u32 s24, s24, s25
    v_mov_b32 v77, 62
    ds_write_b32 v76, v77 offset:1032
    s_waitcnt lgkmcnt(1)
    v_cmp_ne_u32 vcc, 0, v78
    ds_read_b32 v78, v76 offset:1060
    s_cbranch_vccnz L_dp15
    s_waitcnt vmcnt(5)
L_dp15:
    s_waitcnt vmcnt(7)
    buffer_load_dwordx4 v[156:159], v1, s[8:11], s24 offen nt
    v_mfma_f32_16x16x32_bf16 v[48:51], v[112:115], v[4:7], 0
    v_mfma_f32_16x16x32_bf16 v[52:55], v[116:119], v[4:7], 0
    v_mfma_f32_16x16x32_bf16 v[56:59], v[120:123], v[4:7], 0
    v_mfma_f32_16x16x32_bf16 v[60:63], v[124:127], v[4:7], 0
    v_mov_b32_dpp v64, v32 quad_perm:[0,0,0,0] row_mask:0xf bank_mask:0xf
    v_mov_b32_dpp v65, v36 quad_perm:[0,0,0,0] row_mask:0xf bank_mask:0xf
    v_mov_b32_dpp v66, v40 quad_perm:[0,0,0,0] row_mask:0xf bank_mask:0xf
    v_mov_b32_dpp v67, v44 quad_perm:[0,0,0,0] row_mask:0xf bank_mask:0xf
    v_add_f32_dpp v64, v33, v64 quad_perm:[1,1,1,1] row_mask:0xf bank_mask:0xf
    v_add_f32_dpp v65, v37, v65 quad_perm:[1,1,1,1] row_mask:0xf bank_mask:0xf
    v_add_f32_dpp v66, v41, v66 quad_perm:[1,1,1,1] row_mask:0xf bank_mask:0xf
    v_add_f32_dpp v67, v45, v67 quad_perm:[1,1,1,1] row_mask:0xf bank_mask:0xf
    v_add_f32_dpp v64, v34, v64 quad_perm:[2,2,2,2] row_mask:0xf bank_mask:0xf
    v_add_f32_dpp v65, v38, v65 quad_perm:[2,2,2,2] row_mask:0xf bank_mask:0xf
    v_add_f32_dpp v66, v42, v66 quad_perm:[2,2,2,2] row_mask:0xf bank_mask:0xf
    v_add_f32_dpp v67, v46, v67 quad_perm:[2,2,2,2] row_mask:0xf bank_mask:0xf
    v_add_f32_dpp v64, v35, v64 quad_perm:[3,3,3,3] row_mask:0xf bank_mask:0xf
    v_add_f32_dpp v65, v39, v65 quad_perm:[3,3,3,3] row_mask:0xf bank_mask:0xf
    v_add_f32_dpp v66, v43, v66 quad_perm:[3,3,3,3] row_mask:0xf bank_mask:0xf
    v_add_f32_dpp v67, v47, v67 quad_perm:[3,3,3,3] row_mask:0xf bank_mask:0xf
    v_cndmask_b32 v28, v64, v65, s[64:65]
    v_cndmask_b32 v28, v28, v66, s[66:67]
    v_cndmask_b32 v28, v28, v67, s[68:69]
    s_cbranch_vccnz L_dp16
    s_waitcnt vmcnt(5)
L_dp16:
    s_waitcnt vmcnt(7)
    s_mov_b32 s24, 0
    buffer_load_dwordx4 v[160:163], v2, s[12:15], s24 offen nt
    s_add_u32 s24, s24, s25
    v_mov_b32 v77, 64
    ds_write_b32 v76, v77 offset:1032
    s_waitcnt lgkmcnt(1)
    v_cmp_ne_u32 vcc, 0, v78
    ds_read_b32 v78, v76 offset:1060
    s_cbranch_vccnz L_dp17
    s_waitcnt vmcnt(5)
L_dp17:
    s_waitcnt vmcnt(7)
    buffer_load_dwordx4 v[164:167], v2, s[12:15], s24 offen nt
    s_add_u32 s24, s24, s25
    s_cbranch_vccnz L_dp18
    s_waitcnt vmcnt(5)
L_dp18:
    s_waitcnt vmcnt(7)
    buffer_load_dwordx4 v[168:171], v2, s[12:15], s24 offen nt
    s_add_u32 s24, s24, s25
    v_mov_b32 v77, 66
    ds_write_b32 v76, v77 offset:1032
    s_waitcnt lgkmcnt(1)
    v_cmp_ne_u32 vcc, 0, v78
    ds_read_b32 v78, v76 offset:1060
    s_cbranch_vccnz L_dp19
    s_waitcnt vmcnt(5)
L_dp19:
    s_waitcnt vmcnt(7)
    buffer_load_dwordx4 v[172:175], v2, s[12:15], s24 offen nt
    s_add_u32 s24, s24, s25
    v_mfma_f32_16x16x32_bf16 v[32:35], v[128:131], v[4:7], 0
    v_mfma_f32_16x16x32_bf16 v[36:39], v[132:135], v[4:7], 0
    v_mfma_f32_16x16x32_bf16 v[40:43], v[136:139], v[4:7], 0
    v_mfma_f32_16x16x32_bf16 v[44:47], v[140:143], v[4:7], 0
    v_mov_b32_dpp v64, v48 quad_perm:[0,0,0,0] row_mask:0xf bank_mask:0xf
    v_mov_b32_dpp v65, v52 quad_perm:[0,0,0,0] row_mask:0xf bank_mask:0xf
    v_mov_b32_dpp v66, v56 quad_perm:[0,0,0,0] row_mask:0xf bank_mask:0xf
    v_mov_b32_dpp v67, v60 quad_perm:[0,0,0,0] row_mask:0xf bank_mask:0xf
    v_add_f32_dpp v64, v49, v64 quad_perm:[1,1,1,1] row_mask:0xf bank_mask:0xf
    v_add_f32_dpp v65, v53, v65 quad_perm:[1,1,1,1] row_mask:0xf bank_mask:0xf
    v_add_f32_dpp v66, v57, v66 quad_perm:[1,1,1,1] row_mask:0xf bank_mask:0xf
    v_add_f32_dpp v67, v61, v67 quad_perm:[1,1,1,1] row_mask:0xf bank_mask:0xf
    v_add_f32_dpp v64, v50, v64 quad_perm:[2,2,2,2] row_mask:0xf bank_mask:0xf
    v_add_f32_dpp v65, v54, v65 quad_perm:[2,2,2,2] row_mask:0xf bank_mask:0xf
    v_add_f32_dpp v66, v58, v66 quad_perm:[2,2,2,2] row_mask:0xf bank_mask:0xf
    v_add_f32_dpp v67, v62, v67 quad_perm:[2,2,2,2] row_mask:0xf bank_mask:0xf
    v_add_f32_dpp v64, v51, v64 quad_perm:[3,3,3,3] row_mask:0xf bank_mask:0xf
    v_add_f32_dpp v65, v55, v65 quad_perm:[3,3,3,3] row_mask:0xf bank_mask:0xf
    v_add_f32_dpp v66, v59, v66 quad_perm:[3,3,3,3] row_mask:0xf bank_mask:0xf
    v_add_f32_dpp v67, v63, v67 quad_perm:[3,3,3,3] row_mask:0xf bank_mask:0xf
    v_cndmask_b32 v29, v64, v65, s[64:65]
    v_cndmask_b32 v29, v29, v66, s[66:67]
    v_cndmask_b32 v29, v29, v67, s[68:69]
    v_cvt_pk_bf16_f32 v64, v28, v29
    v_lshlrev_b32 v28, 16, v64
    v_and_b32 v29, s90, v64
    v_mul_f32 v28, s88, v28
    v_mul_f32 v29, s88, v29
    v_cvt_pk_bf16_f32 v64, v28, v29
    v_lshlrev_b32 v28, 16, v64
    v_and_b32 v29, s90, v64
    v_max3_f32 v74, v74, v28, v29
    s_cbranch_vccnz L_dp20
    s_waitcnt vmcnt(5)
L_dp20:
    s_waitcnt vmcnt(7)
    buffer_load_dwordx4 v[176:179], v2, s[12:15], s24 offen nt
    s_add_u32 s24, s24, s25
    v_mov_b32 v77, 68
    ds_write_b32 v76, v77 offset:1032
    s_waitcnt lgkmcnt(1)
    v_cmp_ne_u32 vcc, 0, v78
    ds_read_b32 v78, v76 offset:1060
    s_cbranch_vccnz L_dp21
    s_waitcnt vmcnt(5)
L_dp21:
    s_waitcnt vmcnt(7)
    buffer_load_dwordx4 v[180:183], v2, s[12:15], s24 offen nt
    s_add_u32 s24, s24, s25
    s_cbranch_vccnz L_dp22
    s_waitcnt vmcnt(5)
L_dp22:
    s_waitcnt vmcnt(7)
    buffer_load_dwordx4 v[184:187], v2, s[12:15], s24 offen nt
    s_add_u32 s24, s24, s25
    v_mov_b32 v77, 70
    ds_write_b32 v76, v77 offset:1032
    s_waitcnt lgkmcnt(1)
    v_cmp_ne_u32 vcc, 0, v78
    ds_read_b32 v78, v76 offset:1060
    s_cbranch_vccnz L_dp23
    s_waitcnt vmcnt(5)
L_dp23:
    s_waitcnt vmcnt(7)
    buffer_load_dwordx4 v[188:191], v2, s[12:15], s24 offen nt
    s_add_u32 s24, s24, s25
    v_mfma_f32_16x16x32_bf16 v[48:51], v[144:147], v[4:7], 0
    v_mfma_f32_16x16x32_bf16 v[52:55], v[148:151], v[4:7], 0
    v_mfma_f32_16x16x32_bf16 v[56:59], v[152:155], v[4:7], 0
    v_mfma_f32_16x16x32_bf16 v[60:63], v[156:159], v[4:7], 0
    v_mov_b32_dpp v64, v32 quad_perm:[0,0,0,0] row_mask:0xf bank_mask:0xf
    v_mov_b32_dpp v65, v36 quad_perm:[0,0,0,0] row_mask:0xf bank_mask:0xf
    v_mov_b32_dpp v66, v40 quad_perm:[0,0,0,0] row_mask:0xf bank_mask:0xf
    v_mov_b32_dpp v67, v44 quad_perm:[0,0,0,0] row_mask:0xf bank_mask:0xf
    v_add_f32_dpp v64, v33, v64 quad_perm:[1,1,1,1] row_mask:0xf bank_mask:0xf
    v_add_f32_dpp v65, v37, v65 quad_perm:[1,1,1,1] row_mask:0xf bank_mask:0xf
    v_add_f32_dpp v66, v41, v66 quad_perm:[1,1,1,1] row_mask:0xf bank_mask:0xf
    v_add_f32_dpp v67, v45, v67 quad_perm:[1,1,1,1] row_mask:0xf bank_mask:0xf
    v_add_f32_dpp v64, v34, v64 quad_perm:[2,2,2,2] row_mask:0xf bank_mask:0xf
    v_add_f32_dpp v65, v38, v65 quad_perm:[2,2,2,2] row_mask:0xf bank_mask:0xf
    v_add_f32_dpp v66, v42, v66 quad_perm:[2,2,2,2] row_mask:0xf bank_mask:0xf
    v_add_f32_dpp v67, v46, v67 quad_perm:[2,2,2,2] row_mask:0xf bank_mask:0xf
    v_add_f32_dpp v64, v35, v64 quad_perm:[3,3,3,3] row_mask:0xf bank_mask:0xf
    v_add_f32_dpp v65, v39, v65 quad_perm:[3,3,3,3] row_mask:0xf bank_mask:0xf
    v_add_f32_dpp v66, v43, v66 quad_perm:[3,3,3,3] row_mask:0xf bank_mask:0xf
    v_add_f32_dpp v67, v47, v67 quad_perm:[3,3,3,3] row_mask:0xf bank_mask:0xf
    v_cndmask_b32 v30, v64, v65, s[64:65]
    v_cndmask_b32 v30, v30, v66, s[66:67]
    v_cndmask_b32 v30, v30, v67, s[68:69]
    v_mov_b32_dpp v64, v48 quad_perm:[0,0,0,0] row_mask:0xf bank_mask:0xf
    v_mov_b32_dpp v65, v52 quad_perm:[0,0,0,0] row_mask:0xf bank_mask:0xf
    v_mov_b32_dpp v66, v56 quad_perm:[0,0,0,0] row_mask:0xf bank_mask:0xf
    v_mov_b32_dpp v67, v60 quad_perm:[0,0,0,0] row_mask:0xf bank_mask:0xf
    v_add_f32_dpp v64, v49, v64 quad_perm:[1,1,1,1] row_mask:0xf bank_mask:0xf
    v_add_f32_dpp v65, v53, v65 quad_perm:[1,1,1,1] row_mask:0xf bank_mask:0xf
    v_add_f32_dpp v66, v57, v66 quad_perm:[1,1,1,1] row_mask:0xf bank_mask:0xf
    v_add_f32_dpp v67, v61, v67 quad_perm:[1,1,1,1] row_mask:0xf bank_mask:0xf
    v_add_f32_dpp v64, v50, v64 quad_perm:[2,2,2,2] row_mask:0xf bank_mask:0xf
    v_add_f32_dpp v65, v54, v65 quad_perm:[2,2,2,2] row_mask:0xf bank_mask:0xf
    v_add_f32_dpp v66, v58, v66 quad_perm:[2,2,2,2] row_mask:0xf bank_mask:0xf
    v_add_f32_dpp v67, v62, v67 quad_perm:[2,2,2,2] row_mask:0xf bank_mask:0xf
    v_add_f32_dpp v64, v51, v64 quad_perm:[3,3,3,3] row_mask:0xf bank_mask:0xf
    v_add_f32_dpp v65, v55, v65 quad_perm:[3,3,3,3] row_mask:0xf bank_mask:0xf
    v_add_f32_dpp v66, v59, v66 quad_perm:[3,3,3,3] row_mask:0xf bank_mask:0xf
    v_add_f32_dpp v67, v63, v67 quad_perm:[3,3,3,3] row_mask:0xf bank_mask:0xf
    v_cndmask_b32 v31, v64, v65, s[64:65]
    v_cndmask_b32 v31, v31, v66, s[66:67]
    v_cndmask_b32 v31, v31, v67, s[68:69]
    v_cvt_pk_bf16_f32 v64, v30, v31
    v_lshlrev_b32 v30, 16, v64
    v_and_b32 v31, s90, v64
    v_mul_f32 v30, s88, v30
    v_mul_f32 v31, s88, v31
    v_cvt_pk_bf16_f32 v64, v30, v31
    v_lshlrev_b32 v30, 16, v64
    v_and_b32 v31, s90, v64
    v_max3_f32 v74, v74, v30, v31
    s_cbranch_vccnz L_dp24
    s_waitcnt vmcnt(5)
L_dp24:
    s_waitcnt vmcnt(7)
    buffer_load_dwordx4 v[192:195], v2, s[12:15], s24 offen nt
    s_add_u32 s24, s24, s25
    v_mov_b32 v77, 72
    ds_write_b32 v76, v77 offset:1032
    s_waitcnt lgkmcnt(1)
    v_cmp_ne_u32 vcc, 0, v78
    ds_read_b32 v78, v76 offset:1060
    v_lshrrev_b32 v64, 1, v0
    v_lshlrev_b32 v64, 11, v64
    v_and_b32 v65, 1, v0
    v_lshl_add_u32 v1, v65, 9, v64
    s_lshr_b32 s26, s7, 3
    s_lshl_b32 s26, s26, 10
    s_bfe_u32 s27, s7, 0x10002
    s_lshl_b32 s27, s27, 7
    s_add_u32 s26, s26, s27
    s_lshl_b32 s27, s6, 6
    s_add_u32 s26, s26, s27
    s_and_b32 s27, s7, 3
    s_lshl_b32 s27, s27, 4
    s_add_u32 s26, s26, s27
    s_mul_i32 s27, s4, 184320
    s_add_u32 s26, s26, s27
    s_add_u32 s26, s26, 65536
    v_add_u32 v1, s26, v1
    s_lshl_b32 s26, s32, 11
    v_lshlrev_b32 v33, 4, v0
    v_add_u32 v32, s26, v33
    v_mov_b32 v35, 1
    v_max_f32_dpp v74, v74, v74 quad_perm:[1,0,3,2] row_mask:0xf bank_mask:0xf
    s_nop 1
    v_max_f32_dpp v74, v74, v74 quad_perm:[2,3,0,1] row_mask:0xf bank_mask:0xf
    v_mov_b32 v64, v74
    s_nop 1
    v_permlane16_swap_b32 v74, v64
    v_max_f32 v74, v74, v64
    v_mov_b32 v64, v74
    s_nop 1
    v_permlane32_swap_b32 v74, v64
    v_max_f32 v74, v74, v64
    v_mul_f32 v74, s89, v74
    v_fma_f32 v16, v16, s89, -v74
    v_fma_f32 v17, v17, s89, -v74
    v_fma_f32 v18, v18, s89, -v74
    v_fma_f32 v19, v19, s89, -v74
    v_exp_f32 v16, v16
    v_exp_f32 v17, v17
    v_exp_f32 v18, v18
    v_exp_f32 v19, v19
    v_add_f32 v75, v75, v16
    v_add_f32 v75, v75, v17
    v_add_f32 v75, v75, v18
    v_add_f32 v75, v75, v19
    v_cvt_pk_bf16_f32 v16, v16, v16
    v_cvt_pk_bf16_f32 v17, v17, v17
    v_cvt_pk_bf16_f32 v18, v18, v18
    v_cvt_pk_bf16_f32 v19, v19, v19
    s_cbranch_vccnz L_dp25
    s_waitcnt vmcnt(5)
L_dp25:
    s_waitcnt vmcnt(7)
    buffer_load_dwordx4 v[196:199], v2, s[12:15], s24 offen nt
    s_add_u32 s24, s24, s25
    v_fma_f32 v20, v20, s89, -v74
    v_fma_f32 v21, v21, s89, -v74
    v_fma_f32 v22, v22, s89, -v74
    v_fma_f32 v23, v23, s89, -v74
    v_exp_f32 v20, v20
    v_exp_f32 v21, v21
    v_exp_f32 v22, v22
    v_exp_f32 v23, v23
    v_add_f32 v75, v75, v20
    v_add_f32 v75, v75, v21
    v_add_f32 v75, v75, v22
    v_add_f32 v75, v75, v23
    v_cvt_pk_bf16_f32 v20, v20, v20
    v_cvt_pk_bf16_f32 v21, v21, v21
    v_cvt_pk_bf16_f32 v22, v22, v22
    v_cvt_pk_bf16_f32 v23, v23, v23
    v_fma_f32 v24, v24, s89, -v74
    v_fma_f32 v25, v25, s89, -v74
    v_fma_f32 v26, v26, s89, -v74
    v_fma_f32 v27, v27, s89, -v74
    v_exp_f32 v24, v24
    v_exp_f32 v25, v25
    v_exp_f32 v26, v26
    v_exp_f32 v27, v27
    v_add_f32 v75, v75, v24
    v_add_f32 v75, v75, v25
    v_add_f32 v75, v75, v26
    v_add_f32 v75, v75, v27
    v_cvt_pk_bf16_f32 v24, v24, v24
    v_cvt_pk_bf16_f32 v25, v25, v25
    v_cvt_pk_bf16_f32 v26, v26, v26
    v_cvt_pk_bf16_f32 v27, v27, v27
    v_fma_f32 v28, v28, s89, -v74
    v_fma_f32 v29, v29, s89, -v74
    v_fma_f32 v30, v30, s89, -v74
    v_fma_f32 v31, v31, s89, -v74
    v_exp_f32 v28, v28
    v_exp_f32 v29, v29
    v_exp_f32 v30, v30
    v_exp_f32 v31, v31
    v_add_f32 v75, v75, v28
    v_add_f32 v75, v75, v29
    v_add_f32 v75, v75, v30
    v_add_f32 v75, v75, v31
    v_cvt_pk_bf16_f32 v28, v28, v28
    v_cvt_pk_bf16_f32 v29, v29, v29
    v_cvt_pk_bf16_f32 v30, v30, v30
    v_cvt_pk_bf16_f32 v31, v31, v31
    s_cbranch_vccnz L_dp26
    s_waitcnt vmcnt(5)
L_dp26:
    s_waitcnt vmcnt(7)
    buffer_load_dwordx4 v[200:203], v2, s[12:15], s24 offen nt
    s_add_u32 s24, s24, s25
    v_mov_b32 v77, 74
    ds_write_b32 v76, v77 offset:1032
    s_waitcnt lgkmcnt(1)
    v_cmp_ne_u32 vcc, 0, v78
    ds_read_b32 v78, v76 offset:1060
    v_add_f32_dpp v75, v75, v75 quad_perm:[1,0,3,2] row_mask:0xf bank_mask:0xf
    s_nop 1
    v_add_f32_dpp v75, v75, v75 quad_perm:[2,3,0,1] row_mask:0xf bank_mask:0xf
    v_mov_b32 v64, v75
    s_nop 1
    v_permlane16_swap_b32 v75, v64
    v_add_f32 v75, v75, v64
    v_mov_b32 v64, v75
    s_nop 1
    v_permlane32_swap_b32 v75, v64
    v_add_f32 v75, v75, v64
    v_lshlrev_b32 v3, 2, v0
    s_lshl_b32 s26, s32, 2
    v_add_u32 v3, s26, v3
    s_mov_b64 exec, 0x1111
    ds_write_b32 v3, v74 offset:1088
    ds_write_b32 v3, v75 offset:1152
    s_mov_b64 exec, 1
    v_mov_b32 v64, 1
    v_mov_b32 v3, 0
    ds_add_u32 v3, v64 offset:1024
    s_mov_b64 exec, -1
    v_and_b32_dpp v68, v16, v72 quad_perm:[0,0,0,0] row_mask:0xf bank_mask:0xf
    v_and_b32_dpp v69, v16, v73 quad_perm:[0,0,0,0] row_mask:0xf bank_mask:0xf
    s_nop 1
    v_mfma_f32_16x16x16_bf16 v[8:11], v[68:69], v[160:161], v[8:11]
    v_mfma_f32_16x16x16_bf16 v[12:15], v[68:69], v[162:163], v[12:15]
    v_and_b32_dpp v70, v16, v72 quad_perm:[1,1,1,1] row_mask:0xf bank_mask:0xf
    v_and_b32_dpp v71, v16, v73 quad_perm:[1,1,1,1] row_mask:0xf bank_mask:0xf
    s_nop 1
    v_mfma_f32_16x16x16_bf16 v[8:11], v[70:71], v[164:165], v[8:11]
    v_mfma_f32_16x16x16_bf16 v[12:15], v[70:71], v[166:167], v[12:15]
    v_and_b32_dpp v68, v16, v72 quad_perm:[2,2,2,2] row_mask:0xf bank_mask:0xf
    v_and_b32_dpp v69, v16, v73 quad_perm:[2,2,2,2] row_mask:0xf bank_mask:0xf
    s_nop 1
    v_mfma_f32_16x16x16_bf16 v[8:11], v[68:69], v[168:169], v[8:11]
    v_mfma_f32_16x16x16_bf16 v[12:15], v[68:69], v[170:171], v[12:15]
    v_and_b32_dpp v70, v16, v72 quad_perm:[3,3,3,3] row_mask:0xf bank_mask:0xf
    v_and_b32_dpp v71, v16, v73 quad_perm:[3,3,3,3] row_mask:0xf bank_mask:0xf
    s_cbranch_vccnz L_dp27
    s_waitcnt vmcnt(5)
L_dp27:
    s_waitcnt vmcnt(7)
    buffer_load_dwordx4 v[204:207], v2, s[12:15], s24 offen nt
    s_add_u32 s24, s24, s25
    v_mfma_f32_16x16x16_bf16 v[8:11], v[70:71], v[172:173], v[8:11]
    v_mfma_f32_16x16x16_bf16 v[12:15], v[70:71], v[174:175], v[12:15]
    v_and_b32_dpp v68, v17, v72 quad_perm:[0,0,0,0] row_mask:0xf bank_mask:0xf
    v_and_b32_dpp v69, v17, v73 quad_perm:[0,0,0,0] row_mask:0xf bank_mask:0xf
    s_cbranch_vccnz L_dp28
    s_waitcnt vmcnt(5)
L_dp28:
    s_waitcnt vmcnt(7)
    buffer_load_dwordx4 v[208:211], v2, s[12:15], s24 offen nt
    s_add_u32 s24, s24, s25
    v_mov_b32 v77, 76
    ds_write_b32 v76, v77 offset:1032
    s_waitcnt lgkmcnt(1)
    v_cmp_ne_u32 vcc, 0, v78
    ds_read_b32 v78, v76 offset:1060
    v_mfma_f32_16x16x16_bf16 v[8:11], v[68:69], v[176:177], v[8:11]
    v_mfma_f32_16x16x16_bf16 v[12:15], v[68:69], v[178:179], v[12:15]
    v_and_b32_dpp v70, v17, v72 quad_perm:[1,1,1,1] row_mask:0xf bank_mask:0xf
    v_and_b32_dpp v71, v17, v73 quad_perm:[1,1,1,1] row_mask:0xf bank_mask:0xf
    s_cbranch_vccnz L_dp29
    s_waitcnt vmcnt(5)
L_dp29:
    s_waitcnt vmcnt(7)
    buffer_load_dwordx4 v[212:215], v2, s[12:15], s24 offen nt
    s_add_u32 s24, s24, s25
    v_mfma_f32_16x16x16_bf16 v[8:11], v[70:71], v[180:181], v[8:11]
    v_mfma_f32_16x16x16_bf16 v[12:15], v[70:71], v[182:183], v[12:15]
    v_and_b32_dpp v68, v17, v72 quad_perm:[2,2,2,2] row_mask:0xf bank_mask:0xf
    v_and_b32_dpp v69, v17, v73 quad_perm:[2,2,2,2] row_mask:0xf bank_mask:0xf
    s_cbranch_vccnz L_dp30
    s_waitcnt vmcnt(5)
L_dp30:
    s_waitcnt vmcnt(7)
    buffer_load_dwordx4 v[216:219], v2, s[12:15], s24 offen nt
    s_add_u32 s24, s24, s25
    v_mov_b32 v77, 78
    ds_write_b32 v76, v77 offset:1032
    s_waitcnt lgkmcnt(1)
    v_cmp_ne_u32 vcc, 0, v78
    ds_read_b32 v78, v76 offset:1060
    v_mfma_f32_16x16x16_bf16 v[8:11], v[68:69], v[184:185], v[8:11]
    v_mfma_f32_16x16x16_bf16 v[12:15], v[68:69], v[186:187], v[12:15]
    v_and_b32_dpp v70, v17, v72 quad_perm:[3,3,3,3] row_mask:0xf bank_mask:0xf
    v_and_b32_dpp v71, v17, v73 quad_perm:[3,3,3,3] row_mask:0xf bank_mask:0xf
    s_cbranch_vccnz L_dp31
    s_waitcnt vmcnt(5)
L_dp31:
    s_waitcnt vmcnt(7)
    buffer_load_dwordx4 v[220:223], v2, s[12:15], s24 offen nt
    s_add_u32 s24, s24, s25
    v_mfma_f32_16x16x16_bf16 v[8:11], v[70:71], v[188:189], v[8:11]
    v_mfma_f32_16x16x16_bf16 v[12:15], v[70:71], v[190:191], v[12:15]
    v_and_b32_dpp v68, v18, v72 quad_perm:[0,0,0,0] row_mask:0xf bank_mask:0xf
    v_and_b32_dpp v69, v18, v73 quad_perm:[0,0,0,0] row_mask:0xf bank_mask:0xf
    s_cbranch_vccnz L_dp32
    s_waitcnt vmcnt(5)
L_dp32:
    s_waitcnt vmcnt(7)
    buffer_load_dwordx4 v[224:227], v2, s[12:15], s24 offen nt
    s_add_u32 s24, s24, s25
    v_mov_b32 v77, 80
    ds_write_b32 v76, v77 offset:1032
    s_waitcnt lgkmcnt(1)
    v_cmp_ne_u32 vcc, 0, v78
    ds_read_b32 v78, v76 offset:1060
    v_mfma_f32_16x16x16_bf16 v[8:11], v[68:69], v[192:193], v[8:11]
    v_mfma_f32_16x16x16_bf16 v[12:15], v[68:69], v[194:195], v[12:15]
    v_and_b32_dpp v70, v18, v72 quad_perm:[1,1,1,1] row_mask:0xf bank_mask:0xf
    v_and_b32_dpp v71, v18, v73 quad_perm:[1,1,1,1] row_mask:0xf bank_mask:0xf
    s_cbranch_vccnz L_dp33
    s_waitcnt vmcnt(5)
L_dp33:
    s_waitcnt vmcnt(7)
    buffer_load_dwordx4 v[228:231], v2, s[12:15], s24 offen nt
    s_add_u32 s24, s24, s25
    v_mfma_f32_16x16x16_bf16 v[8:11], v[70:71], v[196:197], v[8:11]
    v_mfma_f32_16x16x16_bf16 v[12:15], v[70:71], v[198:199], v[12:15]
    v_and_b32_dpp v68, v18, v72 quad_perm:[2,2,2,2] row_mask:0xf bank_mask:0xf
    v_and_b32_dpp v69, v18, v73 quad_perm:[2,2,2,2] row_mask:0xf bank_mask:0xf
    s_cbranch_vccnz L_dp34
    s_waitcnt vmcnt(5)
L_dp34:
    s_waitcnt vmcnt(7)
    buffer_load_dwordx4 v[232:235], v2, s[12:15], s24 offen nt
    s_add_u32 s24, s24, s25
    v_mov_b32 v77, 82
    ds_write_b32 v76, v77 offset:1032
    s_waitcnt lgkmcnt(1)
    v_cmp_ne_u32 vcc, 0, v78
    ds_read_b32 v78, v76 offset:1060
    v_mfma_f32_16x16x16_bf16 v[8:11], v[68:69], v[200:201], v[8:11]
    v_mfma_f32_16x16x16_bf16 v[12:15], v[68:69], v[202:203], v[12:15]
    v_and_b32_dpp v70, v18, v72 quad_perm:[3,3,3,3] row_mask:0xf bank_mask:0xf
    v_and_b32_dpp v71, v18, v73 quad_perm:[3,3,3,3] row_mask:0xf bank_mask:0xf
    s_cbranch_vccnz L_dp35
    s_waitcnt vmcnt(5)
L_dp35:
    s_waitcnt vmcnt(7)
    buffer_load_dwordx4 v[236:239], v2, s[12:15], s24 offen nt
    s_add_u32 s24, s24, s25
    v_mfma_f32_16x16x16_bf16 v[8:11], v[70:71], v[204:205], v[8:11]
    v_mfma_f32_16x16x16_bf16 v[12:15], v[70:71], v[206:207], v[12:15]
    v_and_b32_dpp v68, v19, v72 quad_perm:[0,0,0,0] row_mask:0xf bank_mask:0xf
    v_and_b32_dpp v69, v19, v73 quad_perm:[0,0,0,0] row_mask:0xf bank_mask:0xf
    s_cbranch_vccnz L_dp36
    s_waitcnt vmcnt(5)
L_dp36:
    s_waitcnt vmcnt(7)
    buffer_load_dwordx4 v[240:243], v2, s[12:15], s24 offen nt
    s_add_u32 s24, s24, s25
    v_mov_b32 v77, 84
    ds_write_b32 v76, v77 offset:1032
    s_waitcnt lgkmcnt(1)
    v_cmp_ne_u32 vcc, 0, v78
    ds_read_b32 v78, v76 offset:1060
    v_mfma_f32_16x16x16_bf16 v[8:11], v[68:69], v[208:209], v[8:11]
    v_mfma_f32_16x16x16_bf16 v[12:15], v[68:69], v[210:211], v[12:15]
    v_and_b32_dpp v70, v19, v72 quad_perm:[1,1,1,1] row_mask:0xf bank_mask:0xf
    v_and_b32_dpp v71, v19, v73 quad_perm:[1,1,1,1] row_mask:0xf bank_mask:0xf
    s_cbranch_vccnz L_dp37
    s_waitcnt vmcnt(5)
L_dp37:
    s_waitcnt vmcnt(7)
    buffer_load_dwordx4 v[244:247], v2, s[12:15], s24 offen nt
    s_add_u32 s24, s24, s25
    v_mfma_f32_16x16x16_bf16 v[8:11], v[70:71], v[212:213], v[8:11]
    v_mfma_f32_16x16x16_bf16 v[12:15], v[70:71], v[214:215], v[12:15]
    v_and_b32_dpp v68, v19, v72 quad_perm:[2,2,2,2] row_mask:0xf bank_mask:0xf
    v_and_b32_dpp v69, v19, v73 quad_perm:[2,2,2,2] row_mask:0xf bank_mask:0xf
    s_cbranch_vccnz L_dp38
    s_waitcnt vmcnt(5)
L_dp38:
    s_waitcnt vmcnt(7)
    buffer_load_dwordx4 v[248:251], v2, s[12:15], s24 offen nt
    s_add_u32 s24, s24, s25
    v_mov_b32 v77, 86
    ds_write_b32 v76, v77 offset:1032
    s_waitcnt lgkmcnt(1)
    v_cmp_ne_u32 vcc, 0, v78
    ds_read_b32 v78, v76 offset:1060
    v_mfma_f32_16x16x16_bf16 v[8:11], v[68:69], v[216:217], v[8:11]
    v_mfma_f32_16x16x16_bf16 v[12:15], v[68:69], v[218:219], v[12:15]
    v_and_b32_dpp v70, v19, v72 quad_perm:[3,3,3,3] row_mask:0xf bank_mask:0xf
    v_and_b32_dpp v71, v19, v73 quad_perm:[3,3,3,3] row_mask:0xf bank_mask:0xf
    s_cbranch_vccnz L_dp39
    s_waitcnt vmcnt(5)
L_dp39:
    s_waitcnt vmcnt(7)
    buffer_load_dwordx4 v[252:255], v2, s[12:15], s24 offen nt
    s_add_u32 s24, s24, s25
    v_mfma_f32_16x16x16_bf16 v[8:11], v[70:71], v[220:221], v[8:11]
    v_mfma_f32_16x16x16_bf16 v[12:15], v[70:71], v[222:223], v[12:15]
    v_and_b32_dpp v68, v20, v72 quad_perm:[0,0,0,0] row_mask:0xf bank_mask:0xf
    v_and_b32_dpp v69, v20, v73 quad_perm:[0,0,0,0] row_mask:0xf bank_mask:0xf
    s_cbranch_vccnz L_dp40
    s_waitcnt vmcnt(5)
L_dp40:
    s_waitcnt vmcnt(7)
    buffer_load_dwordx4 v[80:83], v2, s[12:15], s24 offen nt
    s_add_u32 s24, s24, s25
    v_mov_b32 v77, 88
    ds_write_b32 v76, v77 offset:1032
    s_waitcnt lgkmcnt(1)
    v_cmp_ne_u32 vcc, 0, v78
    ds_read_b32 v78, v76 offset:1060
    v_mfma_f32_16x16x16_bf16 v[8:11], v[68:69], v[224:225], v[8:11]
    v_mfma_f32_16x16x16_bf16 v[12:15], v[68:69], v[226:227], v[12:15]
    v_and_b32_dpp v70, v20, v72 quad_perm:[1,1,1,1] row_mask:0xf bank_mask:0xf
    v_and_b32_dpp v71, v20, v73 quad_perm:[1,1,1,1] row_mask:0xf bank_mask:0xf
    s_cbranch_vccnz L_dp41
    s_waitcnt vmcnt(5)
L_dp41:
    s_waitcnt vmcnt(7)
    buffer_load_dwordx4 v[84:87], v2, s[12:15], s24 offen nt
    s_add_u32 s24, s24, s25
    v_mfma_f32_16x16x16_bf16 v[8:11], v[70:71], v[228:229], v[8:11]
    v_mfma_f32_16x16x16_bf16 v[12:15], v[70:71], v[230:231], v[12:15]
    v_and_b32_dpp v68, v20, v72 quad_perm:[2,2,2,2] row_mask:0xf bank_mask:0xf
    v_and_b32_dpp v69, v20, v73 quad_perm:[2,2,2,2] row_mask:0xf bank_mask:0xf
    s_cbranch_vccnz L_dp42
    s_waitcnt vmcnt(5)
L_dp42:
    s_waitcnt vmcnt(7)
    buffer_load_dwordx4 v[88:91], v2, s[12:15], s24 offen nt
    s_add_u32 s24, s24, s25
    v_mov_b32 v77, 90
    ds_write_b32 v76, v77 offset:1032
    s_waitcnt lgkmcnt(1)
    v_cmp_ne_u32 vcc, 0, v78
    ds_read_b32 v78, v76 offset:1060
    v_mfma_f32_16x16x16_bf16 v[8:11], v[68:69], v[232:233], v[8:11]
    v_mfma_f32_16x16x16_bf16 v[12:15], v[68:69], v[234:235], v[12:15]
    v_and_b32_dpp v70, v20, v72 quad_perm:[3,3,3,3] row_mask:0xf bank_mask:0xf
    v_and_b32_dpp v71, v20, v73 quad_perm:[3,3,3,3] row_mask:0xf bank_mask:0xf
    s_cbranch_vccnz L_dp43
    s_waitcnt vmcnt(5)
L_dp43:
    s_waitcnt vmcnt(7)
    buffer_load_dwordx4 v[92:95], v2, s[12:15], s24 offen nt
    s_add_u32 s24, s24, s25
    v_mfma_f32_16x16x16_bf16 v[8:11], v[70:71], v[236:237], v[8:11]
    v_mfma_f32_16x16x16_bf16 v[12:15], v[70:71], v[238:239], v[12:15]
    v_and_b32_dpp v68, v21, v72 quad_perm:[0,0,0,0] row_mask:0xf bank_mask:0xf
    v_and_b32_dpp v69, v21, v73 quad_perm:[0,0,0,0] row_mask:0xf bank_mask:0xf
    s_cbranch_vccnz L_dp44
    s_waitcnt vmcnt(5)
L_dp44:
    s_waitcnt vmcnt(7)
    buffer_load_dwordx4 v[96:99], v2, s[12:15], s24 offen nt
    s_add_u32 s24, s24, s25
    v_mov_b32 v77, 92
    ds_write_b32 v76, v77 offset:1032
    s_waitcnt lgkmcnt(1)
    v_cmp_ne_u32 vcc, 0, v78
    ds_read_b32 v78, v76 offset:1060
    v_mfma_f32_16x16x16_bf16 v[8:11], v[68:69], v[240:241], v[8:11]
    v_mfma_f32_16x16x16_bf16 v[12:15], v[68:69], v[242:243], v[12:15]
    v_and_b32_dpp v70, v21, v72 quad_perm:[1,1,1,1] row_mask:0xf bank_mask:0xf
    v_and_b32_dpp v71, v21, v73 quad_perm:[1,1,1,1] row_mask:0xf bank_mask:0xf
    s_cbranch_vccnz L_dp45
    s_waitcnt vmcnt(5)
L_dp45:
    s_waitcnt vmcnt(7)
    buffer_load_dwordx4 v[100:103], v2, s[12:15], s24 offen nt
    s_add_u32 s24, s24, s25
    v_mfma_f32_16x16x16_bf16 v[8:11], v[70:71], v[244:245], v[8:11]
    v_mfma_f32_16x16x16_bf16 v[12:15], v[70:71], v[246:247], v[12:15]
    v_and_b32_dpp v68, v21, v72 quad_perm:[2,2,2,2] row_mask:0xf bank_mask:0xf
    v_and_b32_dpp v69, v21, v73 quad_perm:[2,2,2,2] row_mask:0xf bank_mask:0xf
    s_cbranch_vccnz L_dp46
    s_waitcnt vmcnt(5)
L_dp46:
    s_waitcnt vmcnt(7)
    buffer_load_dwordx4 v[104:107], v2, s[12:15], s24 offen nt
    s_add_u32 s24, s24, s25
    v_mov_b32 v77, 94
    ds_write_b32 v76, v77 offset:1032
    s_waitcnt lgkmcnt(1)
    v_cmp_ne_u32 vcc, 0, v78
    ds_read_b32 v78, v76 offset:1060
    v_mfma_f32_16x16x16_bf16 v[8:11], v[68:69], v[248:249], v[8:11]
    v_mfma_f32_16x16x16_bf16 v[12:15], v[68:69], v[250:251], v[12:15]
    v_and_b32_dpp v70, v21, v72 quad_perm:[3,3,3,3] row_mask:0xf bank_mask:0xf
    v_and_b32_dpp v71, v21, v73 quad_perm:[3,3,3,3] row_mask:0xf bank_mask:0xf
    s_cbranch_vccnz L_dp47
    s_waitcnt vmcnt(5)
L_dp47:
    s_waitcnt vmcnt(7)
    buffer_load_dwordx4 v[108:111], v2, s[12:15], s24 offen nt
    s_add_u32 s24, s24, s25
    v_mfma_f32_16x16x16_bf16 v[8:11], v[70:71], v[252:253], v[8:11]
    v_mfma_f32_16x16x16_bf16 v[12:15], v[70:71], v[254:255], v[12:15]
    v_and_b32_dpp v68, v22, v72 quad_perm:[0,0,0,0] row_mask:0xf bank_mask:0xf
    v_and_b32_dpp v69, v22, v73 quad_perm:[0,0,0,0] row_mask:0xf bank_mask:0xf
    s_cbranch_vccnz L_dp48
    s_waitcnt vmcnt(5)
L_dp48:
    s_waitcnt vmcnt(7)
    buffer_load_dwordx4 v[112:115], v2, s[12:15], s24 offen nt
    s_add_u32 s24, s24, s25
    v_mov_b32 v77, 96
    ds_write_b32 v76, v77 offset:1032
    s_waitcnt lgkmcnt(1)
    v_cmp_ne_u32 vcc, 0, v78
    ds_read_b32 v78, v76 offset:1060
    v_mfma_f32_16x16x16_bf16 v[8:11], v[68:69], v[80:81], v[8:11]
    v_mfma_f32_16x16x16_bf16 v[12:15], v[68:69], v[82:83], v[12:15]
    v_and_b32_dpp v70, v22, v72 quad_perm:[1,1,1,1] row_mask:0xf bank_mask:0xf
    v_and_b32_dpp v71, v22, v73 quad_perm:[1,1,1,1] row_mask:0xf bank_mask:0xf
    s_cbranch_vccnz L_dp49
    s_waitcnt vmcnt(5)
L_dp49:
    s_waitcnt vmcnt(7)
    buffer_load_dwordx4 v[116:119], v2, s[12:15], s24 offen nt
    s_add_u32 s24, s24, s25
    v_mfma_f32_16x16x16_bf16 v[8:11], v[70:71], v[84:85], v[8:11]
    v_mfma_f32_16x16x16_bf16 v[12:15], v[70:71], v[86:87], v[12:15]
    v_and_b32_dpp v68, v22, v72 quad_perm:[2,2,2,2] row_mask:0xf bank_mask:0xf
    v_and_b32_dpp v69, v22, v73 quad_perm:[2,2,2,2] row_mask:0xf bank_mask:0xf
    s_cbranch_vccnz L_dp50
    s_waitcnt vmcnt(5)
L_dp50:
    s_waitcnt vmcnt(7)
    buffer_load_dwordx4 v[120:123], v2, s[12:15], s24 offen nt
    s_add_u32 s24, s24, s25
    v_mov_b32 v77, 98
    ds_write_b32 v76, v77 offset:1032
    s_waitcnt lgkmcnt(1)
    v_cmp_ne_u32 vcc, 0, v78
    ds_read_b32 v78, v76 offset:1060
    v_mfma_f32_16x16x16_bf16 v[8:11], v[68:69], v[88:89], v[8:11]
    v_mfma_f32_16x16x16_bf16 v[12:15], v[68:69], v[90:91], v[12:15]
    v_and_b32_dpp v70, v22, v72 quad_perm:[3,3,3,3] row_mask:0xf bank_mask:0xf
    v_and_b32_dpp v71, v22, v73 quad_perm:[3,3,3,3] row_mask:0xf bank_mask:0xf
    s_cbranch_vccnz L_dp51
    s_waitcnt vmcnt(5)
L_dp51:
    s_waitcnt vmcnt(7)
    buffer_load_dwordx4 v[124:127], v2, s[12:15], s24 offen nt
    s_add_u32 s24, s24, s25
    v_mfma_f32_16x16x16_bf16 v[8:11], v[70:71], v[92:93], v[8:11]
    v_mfma_f32_16x16x16_bf16 v[12:15], v[70:71], v[94:95], v[12:15]
    v_and_b32_dpp v68, v23, v72 quad_perm:[0,0,0,0] row_mask:0xf bank_mask:0xf
    v_and_b32_dpp v69, v23, v73 quad_perm:[0,0,0,0] row_mask:0xf bank_mask:0xf
    s_cbranch_vccnz L_dp52
    s_waitcnt vmcnt(5)
L_dp52:
    s_waitcnt vmcnt(7)
    buffer_load_dwordx4 v[128:131], v2, s[12:15], s24 offen nt
    s_add_u32 s24, s24, s25
    v_mov_b32 v77, 100
    ds_write_b32 v76, v77 offset:1032
    s_waitcnt lgkmcnt(1)
    v_cmp_ne_u32 vcc, 0, v78
    ds_read_b32 v78, v76 offset:1060
    v_mfma_f32_16x16x16_bf16 v[8:11], v[68:69], v[96:97], v[8:11]
    v_mfma_f32_16x16x16_bf16 v[12:15], v[68:69], v[98:99], v[12:15]
    v_and_b32_dpp v70, v23, v72 quad_perm:[1,1,1,1] row_mask:0xf bank_mask:0xf
    v_and_b32_dpp v71, v23, v73 quad_perm:[1,1,1,1] row_mask:0xf bank_mask:0xf
    s_cbranch_vccnz L_dp53
    s_waitcnt vmcnt(5)
L_dp53:
    s_waitcnt vmcnt(7)
    buffer_load_dwordx4 v[132:135], v2, s[12:15], s24 offen nt
    s_add_u32 s24, s24, s25
    v_mfma_f32_16x16x16_bf16 v[8:11], v[70:71], v[100:101], v[8:11]
    v_mfma_f32_16x16x16_bf16 v[12:15], v[70:71], v[102:103], v[12:15]
    v_and_b32_dpp v68, v23, v72 quad_perm:[2,2,2,2] row_mask:0xf bank_mask:0xf
    v_and_b32_dpp v69, v23, v73 quad_perm:[2,2,2,2] row_mask:0xf bank_mask:0xf
    s_cbranch_vccnz L_dp54
    s_waitcnt vmcnt(5)
L_dp54:
    s_waitcnt vmcnt(7)
    buffer_load_dwordx4 v[136:139], v2, s[12:15], s24 offen nt
    s_add_u32 s24, s24, s25
    v_mov_b32 v77, 102
    ds_write_b32 v76, v77 offset:1032
    s_waitcnt lgkmcnt(1)
    v_cmp_ne_u32 vcc, 0, v78
    ds_read_b32 v78, v76 offset:1060
    v_mfma_f32_16x16x16_bf16 v[8:11], v[68:69], v[104:105], v[8:11]
    v_mfma_f32_16x16x16_bf16 v[12:15], v[68:69], v[106:107], v[12:15]
    v_and_b32_dpp v70, v23, v72 quad_perm:[3,3,3,3] row_mask:0xf bank_mask:0xf
    v_and_b32_dpp v71, v23, v73 quad_perm:[3,3,3,3] row_mask:0xf bank_mask:0xf
    s_cbranch_vccnz L_dp55
    s_waitcnt vmcnt(5)
L_dp55:
    s_waitcnt vmcnt(7)
    buffer_load_dwordx4 v[140:143], v2, s[12:15], s24 offen nt
    s_add_u32 s24, s24, s25
    v_mfma_f32_16x16x16_bf16 v[8:11], v[70:71], v[108:109], v[8:11]
    v_mfma_f32_16x16x16_bf16 v[12:15], v[70:71], v[110:111], v[12:15]
    v_and_b32_dpp v68, v24, v72 quad_perm:[0,0,0,0] row_mask:0xf bank_mask:0xf
    v_and_b32_dpp v69, v24, v73 quad_perm:[0,0,0,0] row_mask:0xf bank_mask:0xf
    s_cbranch_vccnz L_dp56
    s_waitcnt vmcnt(5)
L_dp56:
    s_waitcnt vmcnt(7)
    buffer_load_dwordx4 v[144:147], v2, s[12:15], s24 offen nt
    s_add_u32 s24, s24, s25
    v_mov_b32 v77, 104
    ds_write_b32 v76, v77 offset:1032
    s_waitcnt lgkmcnt(1)
    v_cmp_ne_u32 vcc, 0, v78
    ds_read_b32 v78, v76 offset:1060
    v_mfma_f32_16x16x16_bf16 v[8:11], v[68:69], v[112:113], v[8:11]
    v_mfma_f32_16x16x16_bf16 v[12:15], v[68:69], v[114:115], v[12:15]
    v_and_b32_dpp v70, v24, v72 quad_perm:[1,1,1,1] row_mask:0xf bank_mask:0xf
    v_and_b32_dpp v71, v24, v73 quad_perm:[1,1,1,1] row_mask:0xf bank_mask:0xf
L_sp57:
    ds_read_b32 v64, v76 offset:1024
    s_waitcnt lgkmcnt(0)
    v_readfirstlane_b32 s26, v64
    s_nop 0
    s_cmp_eq_u32 s26, 4
    s_cbranch_scc1 L_spd57
    s_sleep 1
    s_sub_u32 s29, s29, 1
    s_cbranch_scc0 L_sp57
    s_branch L_abort
L_spd57:
    ds_read_b32 v37, v76 offset:1044
    v_lshrrev_b32 v3, 4, v0
    v_lshlrev_b32 v3, 4, v3
    ds_read_b128 v[40:43], v3 offset:1088
    s_waitcnt lgkmcnt(0)
    v_max3_f32 v64, v40, v41, v42
    v_max_f32 v64, v64, v43
    v_sub_f32 v40, v40, v64
    v_sub_f32 v41, v41, v64
    v_sub_f32 v42, v42, v64
    v_sub_f32 v43, v43, v64
    v_exp_f32 v40, v40
    v_exp_f32 v41, v41
    v_exp_f32 v42, v42
    v_exp_f32 v43, v43
    s_cbranch_vccnz L_dp58
    s_waitcnt vmcnt(5)
L_dp58:
    s_waitcnt vmcnt(7)
    buffer_load_dwordx4 v[148:151], v2, s[12:15], s24 offen nt
    s_add_u32 s24, s24, s25
    v_mfma_f32_16x16x16_bf16 v[8:11], v[70:71], v[116:117], v[8:11]
    v_mfma_f32_16x16x16_bf16 v[12:15], v[70:71], v[118:119], v[12:15]
    v_and_b32_dpp v68, v24, v72 quad_perm:[2,2,2,2] row_mask:0xf bank_mask:0xf
    v_and_b32_dpp v69, v24, v73 quad_perm:[2,2,2,2] row_mask:0xf bank_mask:0xf
    s_cbranch_vccnz L_dp59
    s_waitcnt vmcnt(5)
L_dp59:
    s_waitcnt vmcnt(7)
    buffer_load_dwordx4 v[152:155], v2, s[12:15], s24 offen nt
    s_add_u32 s24, s24, s25
    v_mov_b32 v77, 106
    ds_write_b32 v76, v77 offset:1032
    s_waitcnt lgkmcnt(1)
    v_cmp_ne_u32 vcc, 0, v78
    ds_read_b32 v78, v76 offset:1060
    v_mfma_f32_16x16x16_bf16 v[8:11], v[68:69], v[120:121], v[8:11]
    v_mfma_f32_16x16x16_bf16 v[12:15], v[68:69], v[122:123], v[12:15]
    v_and_b32_dpp v70, v24, v72 quad_perm:[3,3,3,3] row_mask:0xf bank_mask:0xf
    v_and_b32_dpp v71, v24, v73 quad_perm:[3,3,3,3] row_mask:0xf bank_mask:0xf
    s_cbranch_vccnz L_dp60
    s_waitcnt vmcnt(5)
L_dp60:
    s_waitcnt vmcnt(7)
    buffer_load_dwordx4 v[156:159], v2, s[12:15], s24 offen nt
    s_add_u32 s24, s24, s25
    v_mfma_f32_16x16x16_bf16 v[8:11], v[70:71], v[124:125], v[8:11]
    v_mfma_f32_16x16x16_bf16 v[12:15], v[70:71], v[126:127], v[12:15]
    v_and_b32_dpp v68, v25, v72 quad_perm:[0,0,0,0] row_mask:0xf bank_mask:0xf
    v_and_b32_dpp v69, v25, v73 quad_perm:[0,0,0,0] row_mask:0xf bank_mask:0xf
    s_cbranch_vccnz L_dp61
    s_waitcnt vmcnt(5)
L_dp61:
    s_waitcnt vmcnt(7)
    buffer_load_dwordx4 v[160:163], v2, s[12:15], s24 offen nt
    s_add_u32 s24, s24, s25
    v_mov_b32 v77, 108
    ds_write_b32 v76, v77 offset:1032
    s_waitcnt lgkmcnt(1)
    v_cmp_ne_u32 vcc, 0, v78
    ds_read_b32 v78, v76 offset:1060
    v_mfma_f32_16x16x16_bf16 v[8:11], v[68:69], v[128:129], v[8:11]
    v_mfma_f32_16x16x16_bf16 v[12:15], v[68:69], v[130:131], v[12:15]
    v_and_b32_dpp v70, v25, v72 quad_perm:[1,1,1,1] row_mask:0xf bank_mask:0xf
    v_and_b32_dpp v71, v25, v73 quad_perm:[1,1,1,1] row_mask:0xf bank_mask:0xf
    s_cbranch_vccnz L_dp62
    s_waitcnt vmcnt(5)
L_dp62:
    s_waitcnt vmcnt(7)
    buffer_load_dwordx4 v[164:167], v2, s[12:15], s24 offen nt
    s_add_u32 s24, s24, s25
    v_mfma_f32_16x16x16_bf16 v[8:11], v[70:71], v[132:133], v[8:11]
    v_mfma_f32_16x16x16_bf16 v[12:15], v[70:71], v[134:135], v[12:15]
    v_and_b32_dpp v68, v25, v72 quad_perm:[2,2,2,2] row_mask:0xf bank_mask:0xf
    v_and_b32_dpp v69, v25, v73 quad_perm:[2,2,2,2] row_mask:0xf bank_mask:0xf
    s_cbranch_vccnz L_dp63
    s_waitcnt vmcnt(5)
L_dp63:
    s_waitcnt vmcnt(7)
    buffer_load_dwordx4 v[168:171], v2, s[12:15], s24 offen nt
    s_add_u32 s24, s24, s25
    v_mov_b32 v77, 110
    ds_write_b32 v76, v77 offset:1032
    s_waitcnt lgkmcnt(1)
    v_cmp_ne_u32 vcc, 0, v78
    ds_read_b32 v78, v76 offset:1060
    v_mfma_f32_16x16x16_bf16 v[8:11], v[68:69], v[136:137], v[8:11]
    v_mfma_f32_16x16x16_bf16 v[12:15], v[68:69], v[138:139], v[12:15]
    v_and_b32_dpp v70, v25, v72 quad_perm:[3,3,3,3] row_mask:0xf bank_mask:0xf
    v_and_b32_dpp v71, v25, v73 quad_perm:[3,3,3,3] row_mask:0xf bank_mask:0xf
    s_cbranch_vccnz L_dp64
    s_waitcnt vmcnt(5)
L_dp64:
    s_waitcnt vmcnt(7)
    buffer_load_dwordx4 v[172:175], v2, s[12:15], s24 offen nt
    s_add_u32 s24, s24, s25
    v_mfma_f32_16x16x16_bf16 v[8:11], v[70:71], v[140:141], v[8:11]
    v_mfma_f32_16x16x16_bf16 v[12:15], v[70:71], v[142:143], v[12:15]
    v_and_b32_dpp v68, v26, v72 quad_perm:[0,0,0,0] row_mask:0xf bank_mask:0xf
    v_and_b32_dpp v69, v26, v73 quad_perm:[0,0,0,0] row_mask:0xf bank_mask:0xf
    s_cbranch_vccnz L_dp65
    s_waitcnt vmcnt(5)
L_dp65:
    s_waitcnt vmcnt(7)
    buffer_load_dwordx4 v[176:179], v2, s[12:15], s24 offen nt
    s_add_u32 s24, s24, s25
    v_mov_b32 v77, 112
    ds_write_b32 v76, v77 offset:1032
    s_waitcnt lgkmcnt(1)
    v_cmp_ne_u32 vcc, 0, v78
    ds_read_b32 v78, v76 offset:1060
    v_mfma_f32_16x16x16_bf16 v[8:11], v[68:69], v[144:145], v[8:11]
    v_mfma_f32_16x16x16_bf16 v[12:15], v[68:69], v[146:147], v[12:15]
    v_and_b32_dpp v70, v26, v72 quad_perm:[1,1,1,1] row_mask:0xf bank_mask:0xf
    v_and_b32_dpp v71, v26, v73 quad_perm:[1,1,1,1] row_mask:0xf bank_mask:0xf
    s_cbranch_vccnz L_dp66
    s_waitcnt vmcnt(5)
L_dp66:
    s_waitcnt vmcnt(7)
    buffer_load_dwordx4 v[180:183], v2, s[12:15], s24 offen nt
    s_add_u32 s24, s24, s25
    v_mfma_f32_16x16x16_bf16 v[8:11], v[70:71], v[148:149], v[8:11]
    v_mfma_f32_16x16x16_bf16 v[12:15], v[70:71], v[150:151], v[12:15]
    v_and_b32_dpp v68, v26, v72 quad_perm:[2,2,2,2] row_mask:0xf bank_mask:0xf
    v_and_b32_dpp v69, v26, v73 quad_perm:[2,2,2,2] row_mask:0xf bank_mask:0xf
    s_cbranch_vccnz L_dp67
    s_waitcnt vmcnt(5)
L_dp67:
    s_waitcnt vmcnt(7)
    buffer_load_dwordx4 v[184:187], v2, s[12:15], s24 offen nt
    s_add_u32 s24, s24, s25
    v_mov_b32 v77, 114
    ds_write_b32 v76, v77 offset:1032
    s_waitcnt lgkmcnt(1)
    v_cmp_ne_u32 vcc, 0, v78
    ds_read_b32 v78, v76 offset:1060
    v_mfma_f32_16x16x16_bf16 v[8:11], v[68:69], v[152:153], v[8:11]
    v_mfma_f32_16x16x16_bf16 v[12:15], v[68:69], v[154:155], v[12:15]
    v_and_b32_dpp v70, v26, v72 quad_perm:[3,3,3,3] row_mask:0xf bank_mask:0xf
    v_and_b32_dpp v71, v26, v73 quad_perm:[3,3,3,3] row_mask:0xf bank_mask:0xf
    s_cbranch_vccnz L_dp68
    s_waitcnt vmcnt(5)
L_dp68:
    s_waitcnt vmcnt(7)
    buffer_load_dwordx4 v[188:191], v2, s[12:15], s24 offen nt
    s_add_u32 s24, s24, s25
    v_mfma_f32_16x16x16_bf16 v[8:11], v[70:71], v[156:157], v[8:11]
    v_mfma_f32_16x16x16_bf16 v[12:15], v[70:71], v[158:159], v[12:15]
    v_and_b32_dpp v68, v27, v72 quad_perm:[0,0,0,0] row_mask:0xf bank_mask:0xf
    v_and_b32_dpp v69, v27, v73 quad_perm:[0,0,0,0] row_mask:0xf bank_mask:0xf
    s_cbranch_vccnz L_dp69
    s_waitcnt vmcnt(5)
L_dp69:
    s_waitcnt vmcnt(7)
    buffer_load_dwordx4 v[192:195], v2, s[12:15], s24 offen nt
    s_add_u32 s24, s24, s25
    v_mov_b32 v77, 116
    ds_write_b32 v76, v77 offset:1032
    s_waitcnt lgkmcnt(1)
    v_cmp_ne_u32 vcc, 0, v78
    ds_read_b32 v78, v76 offset:1060
    v_mfma_f32_16x16x16_bf16 v[8:11], v[68:69], v[160:161], v[8:11]
    v_mfma_f32_16x16x16_bf16 v[12:15], v[68:69], v[162:163], v[12:15]
    v_and_b32_dpp v70, v27, v72 quad_perm:[1,1,1,1] row_mask:0xf bank_mask:0xf
    v_and_b32_dpp v71, v27, v73 quad_perm:[1,1,1,1] row_mask:0xf bank_mask:0xf
    s_cbranch_vccnz L_dp70
    s_waitcnt vmcnt(5)
L_dp70:
    s_waitcnt vmcnt(7)
    buffer_load_dwordx4 v[196:199], v2, s[12:15], s24 offen nt
    s_add_u32 s24, s24, s25
    v_mfma_f32_16x16x16_bf16 v[8:11], v[70:71], v[164:165], v[8:11]
    v_mfma_f32_16x16x16_bf16 v[12:15], v[70:71], v[166:167], v[12:15]
    v_and_b32_dpp v68, v27, v72 quad_perm:[2,2,2,2] row_mask:0xf bank_mask:0xf
    v_and_b32_dpp v69, v27, v73 quad_perm:[2,2,2,2] row_mask:0xf bank_mask:0xf
    s_cbranch_vccnz L_dp71
    s_waitcnt vmcnt(5)
L_dp71:
    s_waitcnt vmcnt(7)
    buffer_load_dwordx4 v[200:203], v2, s[12:15], s24 offen nt
    s_add_u32 s24, s24, s25
    v_mov_b32 v77, 118
    ds_write_b32 v76, v77 offset:1032
    s_waitcnt lgkmcnt(1)
    v_cmp_ne_u32 vcc, 0, v78
    ds_read_b32 v78, v76 offset:1060
    v_mfma_f32_16x16x16_bf16 v[8:11], v[68:69], v[168:169], v[8:11]
    v_mfma_f32_16x16x16_bf16 v[12:15], v[68:69], v[170:171], v[12:15]
    v_and_b32_dpp v70, v27, v72 quad_perm:[3,3,3,3] row_mask:0xf bank_mask:0xf
    v_and_b32_dpp v71, v27, v73 quad_perm:[3,3,3,3] row_mask:0xf bank_mask:0xf
    s_cbranch_vccnz L_dp72
    s_waitcnt vmcnt(5)
L_dp72:
    s_waitcnt vmcnt(7)
    buffer_load_dwordx4 v[204:207], v2, s[12:15], s24 offen nt
    s_add_u32 s24, s24, s25
    v_mfma_f32_16x16x16_bf16 v[8:11], v[70:71], v[172:173], v[8:11]
    v_mfma_f32_16x16x16_bf16 v[12:15], v[70:71], v[174:175], v[12:15]
    v_and_b32_dpp v68, v28, v72 quad_perm:[0,0,0,0] row_mask:0xf bank_mask:0xf
    v_and_b32_dpp v69, v28, v73 quad_perm:[0,0,0,0] row_mask:0xf bank_mask:0xf
    s_cbranch_vccnz L_dp73
    s_waitcnt vmcnt(5)
L_dp73:
    s_waitcnt vmcnt(7)
    buffer_load_dwordx4 v[208:211], v2, s[12:15], s24 offen nt
    s_add_u32 s24, s24, s25
    v_mov_b32 v77, 120
    ds_write_b32 v76, v77 offset:1032
    s_waitcnt lgkmcnt(1)
    v_cmp_ne_u32 vcc, 0, v78
    ds_read_b32 v78, v76 offset:1060
    v_mfma_f32_16x16x16_bf16 v[8:11], v[68:69], v[176:177], v[8:11]
    v_mfma_f32_16x16x16_bf16 v[12:15], v[68:69], v[178:179], v[12:15]
    v_and_b32_dpp v70, v28, v72 quad_perm:[1,1,1,1] row_mask:0xf bank_mask:0xf
    v_and_b32_dpp v71, v28, v73 quad_perm:[1,1,1,1] row_mask:0xf bank_mask:0xf
    s_cbranch_vccnz L_dp74
    s_waitcnt vmcnt(5)
L_dp74:
    s_waitcnt vmcnt(7)
    buffer_load_dwordx4 v[212:215], v2, s[12:15], s24 offen nt
    s_add_u32 s24, s24, s25
    v_mfma_f32_16x16x16_bf16 v[8:11], v[70:71], v[180:181], v[8:11]
    v_mfma_f32_16x16x16_bf16 v[12:15], v[70:71], v[182:183], v[12:15]
    v_and_b32_dpp v68, v28, v72 quad_perm:[2,2,2,2] row_mask:0xf bank_mask:0xf
    v_and_b32_dpp v69, v28, v73 quad_perm:[2,2,2,2] row_mask:0xf bank_mask:0xf
    s_cbranch_vccnz L_dp75
    s_waitcnt vmcnt(5)
L_dp75:
    s_waitcnt vmcnt(7)
    buffer_load_dwordx4 v[216:219], v2, s[12:15], s24 offen nt
    s_add_u32 s24, s24, s25
    v_mov_b32 v77, 122
    ds_write_b32 v76, v77 offset:1032
    s_waitcnt lgkmcnt(1)
    v_cmp_ne_u32 vcc, 0, v78
    ds_read_b32 v78, v76 offset:1060
    v_mfma_f32_16x16x16_bf16 v[8:11], v[68:69], v[184:185], v[8:11]
    v_mfma_f32_16x16x16_bf16 v[12:15], v[68:69], v[186:187], v[12:15]
    v_and_b32_dpp v70, v28, v72 quad_perm:[3,3,3,3] row_mask:0xf bank_mask:0xf
    v_and_b32_dpp v71, v28, v73 quad_perm:[3,3,3,3] row_mask:0xf bank_mask:0xf
    s_cbranch_vccnz L_dp76
    s_waitcnt vmcnt(5)
L_dp76:
    s_waitcnt vmcnt(7)
    buffer_load_dwordx4 v[220:223], v2, s[12:15], s24 offen nt
    s_add_u32 s24, s24, s25
    v_mfma_f32_16x16x16_bf16 v[8:11], v[70:71], v[188:189], v[8:11]
    v_mfma_f32_16x16x16_bf16 v[12:15], v[70:71], v[190:191], v[12:15]
    v_and_b32_dpp v68, v29, v72 quad_perm:[0,0,0,0] row_mask:0xf bank_mask:0xf
    v_and_b32_dpp v69, v29, v73 quad_perm:[0,0,0,0] row_mask:0xf bank_mask:0xf
    s_cbranch_vccnz L_dp77
    s_waitcnt vmcnt(5)
L_dp77:
    s_waitcnt vmcnt(7)
    buffer_load_dwordx4 v[224:227], v2, s[12:15], s24 offen nt
    s_add_u32 s24, s24, s25
    v_mov_b32 v77, 124
    ds_write_b32 v76, v77 offset:1032
    s_waitcnt lgkmcnt(1)
    v_cmp_ne_u32 vcc, 0, v78
    ds_read_b32 v78, v76 offset:1060
    v_mfma_f32_16x16x16_bf16 v[8:11], v[68:69], v[192:193], v[8:11]
    v_mfma_f32_16x16x16_bf16 v[12:15], v[68:69], v[194:195], v[12:15]
    v_and_b32_dpp v70, v29, v72 quad_perm:[1,1,1,1] row_mask:0xf bank_mask:0xf
    v_and_b32_dpp v71, v29, v73 quad_perm:[1,1,1,1] row_mask:0xf bank_mask:0xf
    s_cbranch_vccnz L_dp78
    s_waitcnt vmcnt(5)
L_dp78:
    s_waitcnt vmcnt(7)
    buffer_load_dwordx4 v[228:231], v2, s[12:15], s24 offen nt
    s_add_u32 s24, s24, s25
    v_mfma_f32_16x16x16_bf16 v[8:11], v[70:71], v[196:197], v[8:11]
    v_mfma_f32_16x16x16_bf16 v[12:15], v[70:71], v[198:199], v[12:15]
    v_and_b32_dpp v68, v29, v72 quad_perm:[2,2,2,2] row_mask:0xf bank_mask:0xf
    v_and_b32_dpp v69, v29, v73 quad_perm:[2,2,2,2] row_mask:0xf bank_mask:0xf
    s_cbranch_vccnz L_dp79
    s_waitcnt vmcnt(5)
L_dp79:
    s_waitcnt vmcnt(7)
    buffer_load_dwordx4 v[232:235], v2, s[12:15], s24 offen nt
    s_add_u32 s24, s24, s25
    v_mfma_f32_16x16x16_bf16 v[8:11], v[68:69], v[200:201], v[8:11]
    v_mfma_f32_16x16x16_bf16 v[12:15], v[68:69], v[202:203], v[12:15]
    v_and_b32_dpp v70, v29, v72 quad_perm:[3,3,3,3] row_mask:0xf bank_mask:0xf
    v_and_b32_dpp v71, v29, v73 quad_perm:[3,3,3,3] row_mask:0xf bank_mask:0xf
    s_cbranch_vccnz L_dp80
    s_waitcnt vmcnt(5)
L_dp80:
    s_waitcnt vmcnt(7)
    buffer_load_dwordx4 v[236:239], v2, s[12:15], s24 offen nt
    v_mfma_f32_16x16x16_bf16 v[8:11], v[70:71], v[204:205], v[8:11]
    v_mfma_f32_16x16x16_bf16 v[12:15], v[70:71], v[206:207], v[12:15]
    v_and_b32_dpp v68, v30, v72 quad_perm:[0,0,0,0] row_mask:0xf bank_mask:0xf
    v_and_b32_dpp v69, v30, v73 quad_perm:[0,0,0,0] row_mask:0xf bank_mask:0xf
    s_waitcnt vmcnt(7)
    s_nop 0
    v_mfma_f32_16x16x16_bf16 v[8:11], v[68:69], v[208:209], v[8:11]
    v_mfma_f32_16x16x16_bf16 v[12:15], v[68:69], v[210:211], v[12:15]
    v_and_b32_dpp v70, v30, v72 quad_perm:[1,1,1,1] row_mask:0xf bank_mask:0xf
    v_and_b32_dpp v71, v30, v73 quad_perm:[1,1,1,1] row_mask:0xf bank_mask:0xf
    s_waitcnt vmcnt(6)
    s_nop 0
    v_mfma_f32_16x16x16_bf16 v[8:11], v[70:71], v[212:213], v[8:11]
    v_mfma_f32_16x16x16_bf16 v[12:15], v[70:71], v[214:215], v[12:15]
    v_and_b32_dpp v68, v30, v72 quad_perm:[2,2,2,2] row_mask:0xf bank_mask:0xf
    v_and_b32_dpp v69, v30, v73 quad_perm:[2,2,2,2] row_mask:0xf bank_mask:0xf
    s_waitcnt vmcnt(5)
    s_nop 0
    v_mfma_f32_16x16x16_bf16 v[8:11], v[68:69], v[216:217], v[8:11]
    v_mfma_f32_16x16x16_bf16 v[12:15], v[68:69], v[218:219], v[12:15]
    v_and_b32_dpp v70, v30, v72 quad_perm:[3,3,3,3] row_mask:0xf bank_mask:0xf
    v_and_b32_dpp v71, v30, v73 quad_perm:[3,3,3,3] row_mask:0xf bank_mask:0xf
    s_waitcnt vmcnt(4)
    s_nop 0
    v_mfma_f32_16x16x16_bf16 v[8:11], v[70:71], v[220:221], v[8:11]
    v_mfma_f32_16x16x16_bf16 v[12:15], v[70:71], v[222:223], v[12:15]
    v_and_b32_dpp v68, v31, v72 quad_perm:[0,0,0,0] row_mask:0xf bank_mask:0xf
    v_and_b32_dpp v69, v31, v73 quad_perm:[0,0,0,0] row_mask:0xf bank_mask:0xf
    s_waitcnt vmcnt(3)
    s_nop 0
    v_mfma_f32_16x16x16_bf16 v[8:11], v[68:69], v[224:225], v[8:11]
    v_mfma_f32_16x16x16_bf16 v[12:15], v[68:69], v[226:227], v[12:15]
    v_and_b32_dpp v70, v31, v72 quad_perm:[1,1,1,1] row_mask:0xf bank_mask:0xf
    v_and_b32_dpp v71, v31, v73 quad_perm:[1,1,1,1] row_mask:0xf bank_mask:0xf
    s_waitcnt vmcnt(2)
    s_nop 0
    v_mfma_f32_16x16x16_bf16 v[8:11], v[70:71], v[228:229], v[8:11]
    v_mfma_f32_16x16x16_bf16 v[12:15], v[70:71], v[230:231], v[12:15]
    v_and_b32_dpp v68, v31, v72 quad_perm:[2,2,2,2] row_mask:0xf bank_mask:0xf
    v_and_b32_dpp v69, v31, v73 quad_perm:[2,2,2,2] row_mask:0xf bank_mask:0xf
    s_waitcnt vmcnt(1)
    s_nop 0
    v_mfma_f32_16x16x16_bf16 v[8:11], v[68:69], v[232:233], v[8:11]
    v_mfma_f32_16x16x16_bf16 v[12:15], v[68:69], v[234:235], v[12:15]
    v_and_b32_dpp v70, v31, v72 quad_perm:[3,3,3,3] row_mask:0xf bank_mask:0xf
    v_and_b32_dpp v71, v31, v73 quad_perm:[3,3,3,3] row_mask:0xf bank_mask:0xf
    s_waitcnt vmcnt(0)
    s_nop 0
    v_mfma_f32_16x16x16_bf16 v[8:11], v[70:71], v[236:237], v[8:11]
    v_mfma_f32_16x16x16_bf16 v[12:15], v[70:71], v[238:239], v[12:15]
    s_nop 6
    ds_write_b128 v32, v[8:11] offset:4096
    ds_write_b128 v32, v[12:15] offset:5120
    s_mov_b64 exec, 1
    ds_add_rtn_u32 v35, v76, v35 offset:1028
    s_mov_b64 exec, -1
    ds_read_b128 v[80:83], v33 offset:4096
    ds_read_b128 v[84:87], v33 offset:6144
    ds_read_b128 v[88:91], v33 offset:8192
    ds_read_b128 v[92:95], v33 offset:10240
    ds_read_b128 v[96:99], v33 offset:5120
    ds_read_b128 v[100:103], v33 offset:7168
    ds_read_b128 v[104:107], v33 offset:9216
    ds_read_b128 v[108:111], v33 offset:11264
    s_waitcnt lgkmcnt(8)
    v_readfirstlane_b32 s26, v35
    s_nop 0
    s_cmp_eq_u32 s26, 3
    s_cbranch_scc0 L_sdone
    s_waitcnt lgkmcnt(7)
    v_pk_mul_f32 v[8:9], v[80:81], v[40:41] op_sel_hi:[1,0]
    v_pk_mul_f32 v[10:11], v[82:83], v[40:41] op_sel_hi:[1,0]
    s_waitcnt lgkmcnt(6)
    v_pk_fma_f32 v[8:9], v[84:85], v[40:41], v[8:9] op_sel:[0,1,0] op_sel_hi:[1,1,1]
    v_pk_fma_f32 v[10:11], v[86:87], v[40:41], v[10:11] op_sel:[0,1,0] op_sel_hi:[1,1,1]
    s_waitcnt lgkmcnt(5)
    v_pk_fma_f32 v[8:9], v[88:89], v[42:43], v[8:9] op_sel_hi:[1,0,1]
    v_pk_fma_f32 v[10:11], v[90:91], v[42:43], v[10:11] op_sel_hi:[1,0,1]
    s_waitcnt lgkmcnt(4)
    v_pk_fma_f32 v[8:9], v[92:93], v[42:43], v[8:9] op_sel:[0,1,0] op_sel_hi:[1,1,1]
    v_pk_fma_f32 v[10:11], v[94:95], v[42:43], v[10:11] op_sel:[0,1,0] op_sel_hi:[1,1,1]
    v_and_or_b32 v8, v8, s91, v37
    v_and_or_b32 v9, v9, s91, v37
    v_and_or_b32 v10, v10, s91, v37
    v_and_or_b32 v11, v11, s91, v37
    s_cmp_eq_u32 s94, 2
    s_cbranch_scc0 L_pubs81
    global_store_dwordx4 v1, v[8:11], s[60:61] offset:0
L_pubd81:
    s_waitcnt lgkmcnt(3)
    v_pk_mul_f32 v[12:13], v[96:97], v[40:41] op_sel_hi:[1,0]
    v_pk_mul_f32 v[14:15], v[98:99], v[40:41] op_sel_hi:[1,0]
    s_waitcnt lgkmcnt(2)
    v_pk_fma_f32 v[12:13], v[100:101], v[40:41], v[12:13] op_sel:[0,1,0] op_sel_hi:[1,1,1]
    v_pk_fma_f32 v[14:15], v[102:103], v[40:41], v[14:15] op_sel:[0,1,0] op_sel_hi:[1,1,1]
    s_waitcnt lgkmcnt(1)
    v_pk_fma_f32 v[12:13], v[104:105], v[42:43], v[12:13] op_sel_hi:[1,0,1]
    v_pk_fma_f32 v[14:15], v[106:107], v[42:43], v[14:15] op_sel_hi:[1,0,1]
    s_waitcnt lgkmcnt(0)
    v_pk_fma_f32 v[12:13], v[108:109], v[42:43], v[12:13] op_sel:[0,1,0] op_sel_hi:[1,1,1]
    v_pk_fma_f32 v[14:15], v[110:111], v[42:43], v[14:15] op_sel:[0,1,0] op_sel_hi:[1,1,1]
    v_and_or_b32 v12, v12, s91, v37
    v_and_or_b32 v13, v13, s91, v37
    v_and_or_b32 v14, v14, s91, v37
    v_and_or_b32 v15, v15, s91, v37
    s_cmp_eq_u32 s94, 2
    s_cbranch_scc0 L_pubs82
    global_store_dwordx4 v1, v[12:15], s[60:61] offset:256
L_pubd82:
L_sdone:
    s_endpgm
L_helper:
    v_mul_u32_u24 v20, 28672, v2
    v_add_u32 v20, v20, v4
    s_and_b32 s26, s5, 7
    s_lshl_b32 s26, s26, 2
    s_lshr_b32 s27, s4, 1
    s_add_u32 s35, s26, s27
    s_lshl_b32 s26, s35, 7
    v_add_u32 v20, s26, v20
    s_bitcmp1_b32 s4, 0
    s_cselect_b32 s12, s50, s48
    s_cselect_b32 s13, s51, s49
    s_mov_b32 s14, 1835008
    s_lshr_b32 s24, s5, 3
    s_lshl_b32 s24, s24, 2
    s_add_u32 s24, s24, s32
    s_mul_i32 s24, s24, 114688
    s_movk_i32 s25, 3584
    s_mov_b32 s19, 0x20000
    s_lshr_b32 s6, s5, 4
    s_mul_i32 s34, s4, 184320
    s_mov_b32 s29, 0x200000
    s_mov_b32 s30, 0x05040100
    s_mov_b32 s31, 0x07060302
    s_mov_b32 s89, 0x3fb8aa3b
    s_mov_b32 s90, 0xffff0000
    s_mov_b32 s91, 0xfffffc00
    s_mov_b32 s23, 0x20000
    s_lshl_b32 s27, s4, 7
    v_add_u32 v4, s27, v4
    v_lshl_add_u32 v23, v2, 13, v4
    v_lshl_add_u32 v54, v2, 12, v4
    v_mov_b32 v26, 1
    s_lshl_b32 s26, s32, 9
    v_lshlrev_b32 v9, 4, v0
    v_add_u32 v27, s26, v9
    s_waitcnt vmcnt(2)
    v_perm_b32 v80, v66, v64, s30
    v_perm_b32 v81, v70, v68, s30
    v_perm_b32 v82, v74, v72, s30
    v_perm_b32 v83, v78, v76, s30
    v_perm_b32 v84, v66, v64, s31
    v_perm_b32 v85, v70, v68, s31
    v_perm_b32 v86, v74, v72, s31
    v_perm_b32 v87, v78, v76, s31
    v_perm_b32 v88, v67, v65, s30
    v_perm_b32 v89, v71, v69, s30
    v_perm_b32 v90, v75, v73, s30
    v_perm_b32 v91, v79, v77, s30
    v_perm_b32 v92, v67, v65, s31
    v_perm_b32 v93, v71, v69, s31
    v_perm_b32 v94, v75, v73, s31
    v_perm_b32 v95, v79, v77, s31
    s_waitcnt vmcnt(0)
    v_mfma_f32_16x16x32_bf16 v[228:231], v[224:227], v[80:83], 0
    v_mfma_f32_16x16x32_bf16 v[232:235], v[224:227], v[84:87], 0
    v_mfma_f32_16x16x32_bf16 v[236:239], v[224:227], v[88:91], 0
    v_mfma_f32_16x16x32_bf16 v[240:243], v[224:227], v[92:95], 0
    v_add_u32 v7, 2654435769, v7
    v_and_b32 v6, 0x3ff, v7
    s_mov_b32 exec_hi, 0
    s_nop 1
    v_mov_b32 v16, v228
    v_mov_b32 v17, v232
    v_mov_b32 v18, v236
    v_mov_b32 v19, v240
    ds_write_b128 v27, v[16:19] offset:4096
    s_mov_b64 exec, 1
    ds_add_u32 v8, v26 offset:1056
    s_mov_b64 exec, -1
    s_cmp_eq_u32 s32, 0
    s_cbranch_scc0 L_hb1
    s_getreg_b32 s33, hwreg(HW_REG_XCC_ID, 0, 4)
    s_add_u32 s33, s33, 1
    v_add_u32 v25, s33, v7
    v_and_b32 v24, 0xff, v25
    v_and_b32 v22, 0xff, v7
    s_mov_b32 s92, 0xffffff00
    v_and_b32 v9, 0x1ff, v9
    v_bfe_u32 v2, v0, 4, 1
    v_lshlrev_b32 v21, 8, v2
    v_and_b32 v2, 1, v0
    v_lshl_add_u32 v21, v2, 7, v21
    v_bfe_u32 v2, v0, 1, 3
    v_lshl_add_u32 v21, v2, 4, v21
    s_lshl_b32 s26, s5, 9
    s_add_u32 s26, s26, s34
    s_add_u32 s26, s26, 131072
    v_add_u32 v21, s26, v21
    v_bfe_u32 v2, v0, 2, 2
    v_lshlrev_b32 v14, 10, v2
    v_lshrrev_b32 v2, 5, v0
    v_lshl_add_u32 v14, v2, 9, v14
    v_bfe_u32 v2, v0, 4, 1
    v_lshl_add_u32 v14, v2, 6, v14
    v_and_b32 v2, 3, v0
    v_lshl_add_u32 v14, v2, 4, v14
    s_lshl_b32 s26, s6, 8
    s_add_u32 s26, s26, s34
    s_add_u32 s26, s26, 135168
    v_add_u32 v14, s26, v14
    v_add_u32 v15, 0x2000, v14
L_sp83:
    ds_read_b32 v2, v8 offset:1056
    s_waitcnt lgkmcnt(0)
    v_readfirstlane_b32 s26, v2
    s_nop 0
    s_cmp_eq_u32 s26, 4
    s_cbranch_scc1 L_spd83
    s_sub_u32 s29, s29, 1
    s_cbranch_scc0 L_sp83
    s_branch L_abort
L_spd83:
    ds_read_b128 v[160:163], v9 offset:4096
    ds_read_b128 v[164:167], v9 offset:4608
    ds_read_b128 v[168:171], v9 offset:5120
    ds_read_b128 v[172:175], v9 offset:5632
    s_waitcnt lgkmcnt(0)
    v_pk_add_f32 v[160:161], v[160:161], v[164:165]
    v_pk_add_f32 v[168:169], v[168:169], v[172:173]
    v_pk_add_f32 v[162:163], v[162:163], v[166:167]
    v_pk_add_f32 v[170:171], v[170:171], v[174:175]
    v_pk_add_f32 v[160:161], v[160:161], v[168:169]
    v_pk_add_f32 v[162:163], v[162:163], v[170:171]
    s_mov_b32 exec_hi, 0
    v_add_u32 v160, 128, v160
    v_and_or_b32 v16, v160, s92, v24
    v_add_u32 v161, 128, v161
    v_and_or_b32 v17, v161, s92, v24
    v_add_u32 v162, 128, v162
    v_and_or_b32 v18, v162, s92, v24
    v_add_u32 v163, 128, v163
    v_and_or_b32 v19, v163, s92, v24
    global_store_dwordx4 v21, v[16:19], s[60:61]
    s_mov_b64 exec, -1
    s_movk_i32 s27, 48
    s_mov_b32 s94, 2
L_qf:
    s_sub_u32 s27, s27, 1
    s_cbranch_scc1 L_qslow
    global_load_dwordx4 v[160:163], v14, s[60:61] offset:-4096 sc1
    global_load_dwordx4 v[164:167], v14, s[60:61] offset:0 sc1
    global_load_dwordx4 v[168:171], v15, s[60:61] offset:-4096 sc1
    global_load_dwordx4 v[172:175], v15, s[60:61] offset:0 sc1
    global_load_dwordx4 v[176:179], v14, s[60:61] offset:-3968 sc1
    global_load_dwordx4 v[180:183], v14, s[60:61] offset:128 sc1
    global_load_dwordx4 v[184:187], v15, s[60:61] offset:-3968 sc1
    global_load_dwordx4 v[188:191], v15, s[60:61] offset:128 sc1
    s_waitcnt vmcnt(0)
    v_bitop3_b32 v1, v160, v161, v25 bitop3:0x7e
    v_bitop3_b32 v2, v162, v163, v25 bitop3:0x7e
    v_bitop3_b32 v3, v164, v165, v25 bitop3:0x7e
    v_bitop3_b32 v4, v166, v167, v25 bitop3:0x7e
    v_bitop3_b32 v5, v168, v169, v25 bitop3:0x7e
    v_bitop3_b32 v28, v170, v171, v25 bitop3:0x7e
    v_bitop3_b32 v29, v172, v173, v25 bitop3:0x7e
    v_bitop3_b32 v30, v174, v175, v25 bitop3:0x7e
    v_or3_b32 v1, v1, v2, v3
    v_or3_b32 v4, v4, v5, v28
    v_or3_b32 v29, v29, v30, v1
    v_or_b32 v4, v4, v29
    v_mov_b32 v31, v4
    v_bitop3_b32 v1, v176, v177, v25 bitop3:0x7e
    v_bitop3_b32 v2, v178, v179, v25 bitop3:0x7e
    v_bitop3_b32 v3, v180, v181, v25 bitop3:0x7e
    v_bitop3_b32 v4, v182, v183, v25 bitop3:0x7e
    v_bitop3_b32 v5, v184, v185, v25 bitop3:0x7e
    v_bitop3_b32 v28, v186, v187, v25 bitop3:0x7e
    v_bitop3_b32 v29, v188, v189, v25 bitop3:0x7e
    v_bitop3_b32 v30, v190, v191, v25 bitop3:0x7e
    v_or3_b32 v1, v1, v2, v3
    v_or3_b32 v4, v4, v5, v28
    v_or3_b32 v29, v29, v30, v31
    v_or3_b32 v1, v1, v4, v29
    v_and_b32 v1, 0xff, v1
    v_cmp_ne_u32 vcc, 0, v1
    s_nop 0
    s_cbranch_vccz L_qok
    s_sleep 1
    s_branch L_qf
L_qok:
    v_and_b32 v160, s92, v160
    v_and_b32 v161, s92, v161
    v_and_b32 v162, s92, v162
    v_and_b32 v163, s92, v163
    v_and_b32 v164, s92, v164
    v_and_b32 v165, s92, v165
    v_and_b32 v166, s92, v166
    v_and_b32 v167, s92, v167
    v_and_b32 v168, s92, v168
    v_and_b32 v169, s92, v169
    v_and_b32 v170, s92, v170
    v_and_b32 v171, s92, v171
    v_and_b32 v172, s92, v172
    v_and_b32 v173, s92, v173
    v_and_b32 v174, s92, v174
    v_and_b32 v175, s92, v175
    v_and_b32 v176, s92, v176
    v_and_b32 v177, s92, v177
    v_and_b32 v178, s92, v178
    v_and_b32 v179, s92, v179
    v_and_b32 v180, s92, v180
    v_and_b32 v181, s92, v181
    v_and_b32 v182, s92, v182
    v_and_b32 v183, s92, v183
    v_and_b32 v184, s92, v184
    v_and_b32 v185, s92, v185
    v_and_b32 v186, s92, v186
    v_and_b32 v187, s92, v187
    v_and_b32 v188, s92, v188
    v_and_b32 v189, s92, v189
    v_and_b32 v190, s92, v190
    v_and_b32 v191, s92, v191
    v_pk_add_f32 v[160:161], v[160:161], v[164:165]
    v_pk_add_f32 v[168:169], v[168:169], v[172:173]
    v_pk_add_f32 v[162:163], v[162:163], v[166:167]
    v_pk_add_f32 v[170:171], v[170:171], v[174:175]
    v_pk_add_f32 v[160:161], v[160:161], v[168:169]
    v_pk_add_f32 v[162:163], v[162:163], v[170:171]
    v_pk_add_f32 v[176:177], v[176:177], v[180:181]
    v_pk_add_f32 v[184:185], v[184:185], v[188:189]
    v_pk_add_f32 v[178:179], v[178:179], v[182:183]
    v_pk_add_f32 v[186:187], v[186:187], v[190:191]
    v_pk_add_f32 v[176:177], v[176:177], v[184:185]
    v_pk_add_f32 v[178:179], v[178:179], v[186:187]
    v_cvt_pk_bf16_f32 v28, v160, v161
    v_cvt_pk_bf16_f32 v29, v162, v163
    v_cvt_pk_bf16_f32 v30, v176, v177
    v_cvt_pk_bf16_f32 v31, v178, v179
    v_lshlrev_b32 v3, 4, v0
    ds_write_b128 v3, v[28:31] offset:0
    v_mov_b32 v24, s94
    v_mov_b32 v25, v6
    ds_write_b64 v8, v[24:25] offset:1040
    s_and_b32 s26, s5, 7
    s_cmp_eq_u32 s26, 7
    s_cbranch_scc1 L_nojob84
    buffer_load_dwordx2 v[96:97], v20, s[12:15], s24 offen nt
    s_add_u32 s24, s24, s25
    buffer_load_dwordx2 v[98:99], v20, s[12:15], s24 offen nt
    s_add_u32 s24, s24, s25
    s_waitcnt vmcnt(1)
    buffer_load_dwordx2 v[100:101], v20, s[12:15], s24 offen nt
    s_add_u32 s24, s24, s25
    s_waitcnt vmcnt(1)
    buffer_load_dwordx2 v[102:103], v20, s[12:15], s24 offen nt
    s_add_u32 s24, s24, s25
    s_waitcnt vmcnt(1)
    buffer_load_dwordx2 v[104:105], v20, s[12:15], s24 offen nt
    s_add_u32 s24, s24, s25
    s_waitcnt vmcnt(1)
    buffer_load_dwordx2 v[106:107], v20, s[12:15], s24 offen nt
    s_add_u32 s24, s24, s25
    s_waitcnt vmcnt(1)
    buffer_load_dwordx2 v[108:109], v20, s[12:15], s24 offen nt
    s_add_u32 s24, s24, s25
    s_waitcnt vmcnt(1)
    buffer_load_dwordx2 v[110:111], v20, s[12:15], s24 offen nt
    s_waitcnt vmcnt(0)
    v_perm_b32 v112, v98, v96, s30
    v_perm_b32 v113, v102, v100, s30
    v_perm_b32 v114, v106, v104, s30
    v_perm_b32 v115, v110, v108, s30
    v_perm_b32 v116, v98, v96, s31
    v_perm_b32 v117, v102, v100, s31
    v_perm_b32 v118, v106, v104, s31
    v_perm_b32 v119, v110, v108, s31
    v_perm_b32 v120, v99, v97, s30
    v_perm_b32 v121, v103, v101, s30
    v_perm_b32 v122, v107, v105, s30
    v_perm_b32 v123, v111, v109, s30
    v_perm_b32 v124, v99, v97, s31
    v_perm_b32 v125, v103, v101, s31
    v_perm_b32 v126, v107, v105, s31
    v_perm_b32 v127, v111, v109, s31
    v_mfma_f32_16x16x32_bf16 v[228:231], v[224:227], v[112:115], 0
    v_mfma_f32_16x16x32_bf16 v[232:235], v[224:227], v[116:119], 0
    v_mfma_f32_16x16x32_bf16 v[236:239], v[224:227], v[120:123], 0
    v_mfma_f32_16x16x32_bf16 v[240:243], v[224:227], v[124:127], 0
    s_mov_b32 exec_hi, 0
    s_nop 3
    v_mov_b32 v40, v228
    v_mov_b32 v41, v232
    v_mov_b32 v42, v236
    v_mov_b32 v43, v240
    ds_write_b128 v27, v[40:43] offset:12288
    s_mov_b64 exec, 1
    ds_add_u32 v8, v26 offset:1048
    s_mov_b64 exec, -1
L_nojob84:
    s_branch L_hq
L_hb1:
    s_and_b32 s26, s5, 7
    s_cmp_eq_u32 s26, 7
    s_cbranch_scc1 L_nojob85
    buffer_load_dwordx2 v[96:97], v20, s[12:15], s24 offen nt
    s_add_u32 s24, s24, s25
    buffer_load_dwordx2 v[98:99], v20, s[12:15], s24 offen nt
    s_add_u32 s24, s24, s25
    s_waitcnt vmcnt(1)
    buffer_load_dwordx2 v[100:101], v20, s[12:15], s24 offen nt
    s_add_u32 s24, s24, s25
    s_waitcnt vmcnt(1)
    buffer_load_dwordx2 v[102:103], v20, s[12:15], s24 offen nt
    s_add_u32 s24, s24, s25
    s_waitcnt vmcnt(1)
    buffer_load_dwordx2 v[104:105], v20, s[12:15], s24 offen nt
    s_add_u32 s24, s24, s25
    s_waitcnt vmcnt(1)
    buffer_load_dwordx2 v[106:107], v20, s[12:15], s24 offen nt
    s_add_u32 s24, s24, s25
    s_waitcnt vmcnt(1)
    buffer_load_dwordx2 v[108:109], v20, s[12:15], s24 offen nt
    s_add_u32 s24, s24, s25
    s_waitcnt vmcnt(1)
    buffer_load_dwordx2 v[110:111], v20, s[12:15], s24 offen nt
    s_waitcnt vmcnt(0)
    v_perm_b32 v112, v98, v96, s30
    v_perm_b32 v113, v102, v100, s30
    v_perm_b32 v114, v106, v104, s30
    v_perm_b32 v115, v110, v108, s30
    v_perm_b32 v116, v98, v96, s31
    v_perm_b32 v117, v102, v100, s31
    v_perm_b32 v118, v106, v104, s31
    v_perm_b32 v119, v110, v108, s31
    v_perm_b32 v120, v99, v97, s30
    v_perm_b32 v121, v103, v101, s30
    v_perm_b32 v122, v107, v105, s30
    v_perm_b32 v123, v111, v109, s30
    v_perm_b32 v124, v99, v97, s31
    v_perm_b32 v125, v103, v101, s31
    v_perm_b32 v126, v107, v105, s31
    v_perm_b32 v127, v111, v109, s31
    v_mfma_f32_16x16x32_bf16 v[228:231], v[224:227], v[112:115], 0
    v_mfma_f32_16x16x32_bf16 v[232:235], v[224:227], v[116:119], 0
    v_mfma_f32_16x16x32_bf16 v[236:239], v[224:227], v[120:123], 0
    v_mfma_f32_16x16x32_bf16 v[240:243], v[224:227], v[124:127], 0
    s_mov_b32 exec_hi, 0
    s_nop 3
    v_mov_b32 v40, v228
    v_mov_b32 v41, v232
    v_mov_b32 v42, v236
    v_mov_b32 v43, v240
    ds_write_b128 v27, v[40:43] offset:12288
    s_mov_b64 exec, 1
    ds_add_u32 v8, v26 offset:1048
    s_mov_b64 exec, -1
L_nojob85:
L_sp86:
    ds_read_b32 v2, v8 offset:1040
    s_waitcnt lgkmcnt(0)
    v_readfirstlane_b32 s26, v2
    s_nop 0
    s_cmp_lg_u32 s26, 0
    s_cbranch_scc1 L_spd86
    s_sleep 4
    s_sub_u32 s29, s29, 1
    s_cbranch_scc0 L_sp86
    s_branch L_abort
L_spd86:
    s_mov_b32 s94, s26
L_hq:
    v_and_b32 v3, 31, v0
    v_lshlrev_b32 v3, 11, v3
    s_lshl_b32 s26, s5, 2
    s_add_u32 s26, s26, s32
    s_lshl_b32 s26, s26, 4
    s_add_u32 s26, s26, s34
    v_add_u32 v15, s26, v3
    v_mov_b32 v96, 0
    v_mov_b32 v97, 0
    v_mov_b32 v98, 0
    v_mov_b32 v99, 0
    v_mov_b32 v100, 0
    v_mov_b32 v101, 0
    v_mov_b32 v102, 0
    v_mov_b32 v103, 0
    s_mov_b32 s16, s44
    s_mov_b32 s17, s45
    s_mov_b32 s18, 0x400000
    s_mov_b32 s20, s52
    s_mov_b32 s21, s53
    s_mov_b32 s22, 1835008
    s_lshl_b32 s26, s5, 11
    s_add_u32 s26, s26, s34
    v_lshl_add_u32 v21, v0, 4, s26
    v_add_u32 v14, 65536, v21
    v_and_b32 v22, 0xffff, v7
    s_cmp_eq_u32 s32, 0
    s_cbranch_scc1 L_h0mid
    s_cmp_eq_u32 s32, 2
    s_cbranch_scc1 L_ctl
    s_cmp_eq_u32 s32, 3
    s_cbranch_scc1 L_h3mid
    s_cmp_eq_u32 s32, 1
    s_cbranch_scc0 L_late
    v_lshrrev_b32 v1, 5, v0
    v_lshlrev_b32 v1, 4, v1
    v_and_b32 v2, 15, v0
    v_add_u32 v1, v1, v2
    v_lshlrev_b32 v1, 5, v1
    v_bfe_u32 v2, v0, 4, 1
    v_lshl_add_u32 v2, v2, 10, v1
    global_load_dwordx4 v[56:59], v2, s[36:37]
    global_load_dwordx4 v[60:63], v2, s[36:37] offset:16
    global_load_dwordx4 v[40:43], v1, s[54:55]
    global_load_dwordx4 v[44:47], v1, s[54:55] offset:16
    v_mov_b32 v10, 0
    s_waitcnt vmcnt(0)
    v_lshlrev_b32 v48, 16, v56
    v_and_b32 v49, s90, v56
    v_lshlrev_b32 v50, 16, v40
    v_and_b32 v51, s90, v40
    v_mul_f32 v48, v48, v50
    v_mul_f32 v49, v49, v51
    v_cvt_pk_bf16_f32 v48, v48, v49
    v_and_b32 v49, s90, v48
    v_lshlrev_b32 v48, 16, v48
    v_add_f32 v10, v10, v48
    v_add_f32 v10, v10, v49
    v_lshlrev_b32 v48, 16, v57
    v_and_b32 v49, s90, v57
    v_lshlrev_b32 v50, 16, v41
    v_and_b32 v51, s90, v41
    v_mul_f32 v48, v48, v50
    v_mul_f32 v49, v49, v51
    v_cvt_pk_bf16_f32 v48, v48, v49
    v_and_b32 v49, s90, v48
    v_lshlrev_b32 v48, 16, v48
    v_add_f32 v10, v10, v48
    v_add_f32 v10, v10, v49
    v_lshlrev_b32 v48, 16, v58
    v_and_b32 v49, s90, v58
    v_lshlrev_b32 v50, 16, v42
    v_and_b32 v51, s90, v42
    v_mul_f32 v48, v48, v50
    v_mul_f32 v49, v49, v51
    v_cvt_pk_bf16_f32 v48, v48, v49
    v_and_b32 v49, s90, v48
    v_lshlrev_b32 v48, 16, v48
    v_add_f32 v10, v10, v48
    v_add_f32 v10, v10, v49
    v_lshlrev_b32 v48, 16, v59
    v_and_b32 v49, s90, v59
    v_lshlrev_b32 v50, 16, v43
    v_and_b32 v51, s90, v43
    v_mul_f32 v48, v48, v50
    v_mul_f32 v49, v49, v51
    v_cvt_pk_bf16_f32 v48, v48, v49
    v_and_b32 v49, s90, v48
    v_lshlrev_b32 v48, 16, v48
    v_add_f32 v10, v10, v48
    v_add_f32 v10, v10, v49
    v_lshlrev_b32 v48, 16, v60
    v_and_b32 v49, s90, v60
    v_lshlrev_b32 v50, 16, v44
    v_and_b32 v51, s90, v44
    v_mul_f32 v48, v48, v50
    v_mul_f32 v49, v49, v51
    v_cvt_pk_bf16_f32 v48, v48, v49
    v_and_b32 v49, s90, v48
    v_lshlrev_b32 v48, 16, v48
    v_add_f32 v10, v10, v48
    v_add_f32 v10, v10, v49
    v_lshlrev_b32 v48, 16, v61
    v_and_b32 v49, s90, v61
    v_lshlrev_b32 v50, 16, v45
    v_and_b32 v51, s90, v45
    v_mul_f32 v48, v48, v50
    v_mul_f32 v49, v49, v51
    v_cvt_pk_bf16_f32 v48, v48, v49
    v_and_b32 v49, s90, v48
    v_lshlrev_b32 v48, 16, v48
    v_add_f32 v10, v10, v48
    v_add_f32 v10, v10, v49
    v_lshlrev_b32 v48, 16, v62
    v_and_b32 v49, s90, v62
    v_lshlrev_b32 v50, 16, v46
    v_and_b32 v51, s90, v46
    v_mul_f32 v48, v48, v50
    v_mul_f32 v49, v49, v51
    v_cvt_pk_bf16_f32 v48, v48, v49
    v_and_b32 v49, s90, v48
    v_lshlrev_b32 v48, 16, v48
    v_add_f32 v10, v10, v48
    v_add_f32 v10, v10, v49
    v_lshlrev_b32 v48, 16, v63
    v_and_b32 v49, s90, v63
    v_lshlrev_b32 v50, 16, v47
    v_and_b32 v51, s90, v47
    v_mul_f32 v48, v48, v50
    v_mul_f32 v49, v49, v51
    v_cvt_pk_bf16_f32 v48, v48, v49
    v_and_b32 v49, s90, v48
    v_lshlrev_b32 v48, 16, v48
    v_add_f32 v10, v10, v48
    v_add_f32 v10, v10, v49
    s_nop 1
    v_add_f32_dpp v10, v10, v10 row_ror:8 row_mask:0xf bank_mask:0xf
    s_nop 1
    v_add_f32_dpp v10, v10, v10 row_ror:4 row_mask:0xf bank_mask:0xf
    s_nop 1
    v_add_f32_dpp v10, v10, v10 row_ror:2 row_mask:0xf bank_mask:0xf
    s_nop 1
    v_add_f32_dpp v10, v10, v10 row_ror:1 row_mask:0xf bank_mask:0xf
    v_mov_b32 v48, v10
    s_nop 1
    v_permlane32_swap_b32 v10, v48
    v_add_f32 v10, v10, v48
    v_cvt_pk_bf16_f32 v10, v10, v10
    v_and_b32 v10, s90, v10
    v_mul_f32 v10, s89, v10
    v_exp_f32 v10, -v10
    s_nop 0
    v_add_f32 v10, 1.0, v10
    v_rcp_f32 v10, v10
    s_nop 0
    v_cvt_pk_bf16_f32 v10, v10, v10
    v_and_b32 v10, s90, v10
    v_sub_f32 v11, 1.0, v10
    v_cvt_pk_bf16_f32 v11, v11, v11
    v_and_b32 v11, s90, v11
    v_lshlrev_b32 v1, 3, v0
    ds_write_b64 v1, v[10:11] offset:3072
    s_branch L_hrdy
L_ctl:
    s_cmp_eq_u32 s94, 2
    s_cbranch_scc0 L_late
    s_add_u32 s26, s34, 149760
    v_and_b32 v1, 31, v0
    v_lshl_add_u32 v40, v1, 2, s26
    s_lshl_b32 s27, s5, 2
    s_add_u32 s26, s26, s27
    v_mov_b32 v41, s26
    v_lshlrev_b32 v42, 16, v7
    s_getreg_b32 s33, hwreg(HW_REG_XCC_ID, 0, 1)
    s_cmp_eq_u32 s33, 0
    s_cselect_b32 s33, 2, 2
L_sp87:
    ds_read_b32 v43, v8 offset:1032
    s_waitcnt lgkmcnt(0)
    v_readfirstlane_b32 s26, v43
    s_nop 0
    s_cmp_ge_u32 s26, 48
    s_cbranch_scc1 L_spd87
    s_sleep 4
    s_sub_u32 s29, s29, 1
    s_cbranch_scc0 L_sp87
    s_branch L_abort
L_spd87:
L_ctl1:
    v_or_b32 v44, v42, v43
    s_mov_b64 exec, 1
    global_store_dword v41, v44, s[60:61]
    s_mov_b64 exec, -1
    global_load_dword v45, v40, s[60:61] sc1
    s_waitcnt vmcnt(0)
    v_xor_b32 v45, v45, v42
    v_cmp_gt_u32 vcc, 0x100, v45
    s_nop 1
    v_cndmask_b32 v45, 40, v45, vcc
    s_nop 1
    v_add_u32_dpp v45, v45, v45 row_ror:8 row_mask:0xf bank_mask:0xf
    s_nop 1
    v_add_u32_dpp v45, v45, v45 row_ror:4 row_mask:0xf bank_mask:0xf
    s_nop 1
    v_add_u32_dpp v45, v45, v45 row_ror:2 row_mask:0xf bank_mask:0xf
    s_nop 1
    v_add_u32_dpp v45, v45, v45 row_ror:1 row_mask:0xf bank_mask:0xf
    v_mov_b32 v46, v45
    s_nop 1
    v_permlane16_swap_b32 v45, v46
    v_add_u32 v45, v45, v46
    v_add_u32 v46, s33, v43
    v_lshlrev_b32 v46, 5, v46
    v_cmp_lt_u32 vcc, v46, v45
    s_nop 1
    v_cndmask_b32 v46, 0, 1, vcc
    ds_write_b32 v8, v46 offset:1060
    ds_read_b32 v43, v8 offset:1032
    s_waitcnt lgkmcnt(0)
    v_readfirstlane_b32 s26, v43
    s_nop 0
    s_cmp_ge_u32 s26, 122
    s_cbranch_scc1 L_late
    s_sub_u32 s29, s29, 1
    s_cbranch_scc0 L_ctl1
    s_branch L_abort
L_h3mid:
    s_and_b32 s26, s5, 7
    s_cmp_eq_u32 s26, 7
    s_cbranch_scc1 L_late
    s_lshl_b32 s26, s35, 1
    s_and_b32 s27, s4, 1
    s_add_u32 s26, s26, s27
    s_lshl_b32 s26, s26, 2
    s_lshr_b32 s27, s5, 3
    s_add_u32 s26, s26, s27
    s_lshl_b32 s26, s26, 9
    s_add_u32 s26, s26, 1474560
    v_and_b32 v9, 0x1ff, v9
    v_add_u32 v1, s26, v9
L_sp88:
    ds_read_b32 v2, v8 offset:1048
    s_waitcnt lgkmcnt(0)
    v_readfirstlane_b32 s26, v2
    s_nop 0
    s_cmp_eq_u32 s26, 4
    s_cbranch_scc1 L_spd88
    s_sleep 4
    s_sub_u32 s29, s29, 1
    s_cbranch_scc0 L_sp88
    s_branch L_abort
L_spd88:
    ds_read_b128 v[160:163], v9 offset:12288
    ds_read_b128 v[164:167], v9 offset:12800
    ds_read_b128 v[168:171], v9 offset:13312
    ds_read_b128 v[172:175], v9 offset:13824
    s_waitcnt lgkmcnt(0)
    v_pk_add_f32 v[160:161], v[160:161], v[164:165]
    v_pk_add_f32 v[168:169], v[168:169], v[172:173]
    v_pk_add_f32 v[162:163], v[162:163], v[166:167]
    v_pk_add_f32 v[170:171], v[170:171], v[174:175]
    v_pk_add_f32 v[160:161], v[160:161], v[168:169]
    v_pk_add_f32 v[162:163], v[162:163], v[170:171]
    s_mov_b32 exec_hi, 0
    v_and_or_b32 v160, v160, s91, v6
    v_and_or_b32 v161, v161, s91, v6
    v_and_or_b32 v162, v162, s91, v6
    v_and_or_b32 v163, v163, s91, v6
    global_store_dwordx4 v1, v[160:163], s[60:61] sc1
    s_mov_b64 exec, -1
    s_branch L_late
L_h0mid:
L_sp89:
    ds_read_b32 v2, v8 offset:1024
    s_waitcnt lgkmcnt(0)
    v_readfirstlane_b32 s26, v2
    s_nop 0
    s_cmp_eq_u32 s26, 4
    s_cbranch_scc1 L_spd89
    s_sleep 4
    s_sub_u32 s29, s29, 1
    s_cbranch_scc0 L_sp89
    s_branch L_abort
L_spd89:
    v_and_b32 v1, 3, v0
    v_lshlrev_b32 v2, 4, v1
    ds_read_b128 v[36:39], v2 offset:1088
    ds_read_b128 v[28:31], v2 offset:1152
    s_lshl_b32 s26, s5, 6
    s_add_u32 s26, s26, s34
    s_add_u32 s26, s26, 147456
    v_add_u32 v1, s26, v2
    v_mov_b32 v40, v7
    v_mov_b32 v43, v7
    s_waitcnt lgkmcnt(0)
    v_max3_f32 v41, v36, v37, v38
    v_max_f32 v41, v41, v39
    v_sub_f32 v36, v36, v41
    v_sub_f32 v37, v37, v41
    v_sub_f32 v38, v38, v41
    v_sub_f32 v39, v39, v41
    v_exp_f32 v36, v36
    v_exp_f32 v37, v37
    v_exp_f32 v38, v38
    v_exp_f32 v39, v39
    v_mul_f32 v42, v36, v28
    v_fmac_f32 v42, v37, v29
    v_fmac_f32 v42, v38, v30
    v_fmac_f32 v42, v39, v31
    s_mov_b64 exec, 0xf
    s_cmp_eq_u32 s94, 2
    s_cbranch_scc0 L_pubs90
    global_store_dwordx4 v1, v[40:43], s[60:61]
L_pubd90:
    s_mov_b64 exec, -1
    v_bfe_u32 v1, v0, 2, 1
    v_lshlrev_b32 v1, 4, v1
    v_bfe_u32 v2, v0, 3, 1
    v_lshl_add_u32 v1, v2, 2, v1
    v_and_b32 v2, 3, v0
    v_add_u32 v1, v1, v2
    s_lshr_b32 s27, s5, 3
    s_lshl_b32 s27, s27, 4
    s_add_u32 s26, s34, s27
    s_add_u32 s26, s26, 147456
    v_lshl_add_u32 v25, v1, 6, s26
    v_bfe_u32 v1, v0, 3, 1
    v_and_b32 v2, 3, v0
    v_lshl_add_u32 v1, v1, 2, v2
    v_mul_u32_u24 v20, 184320, v1
L_sp91:
    ds_read_b32 v2, v8 offset:1032
    s_waitcnt lgkmcnt(0)
    v_readfirstlane_b32 s26, v2
    s_nop 0
    s_cmp_ge_u32 s26, 88
    s_cbranch_scc1 L_spd91
    s_sleep 4
    s_sub_u32 s29, s29, 1
    s_cbranch_scc0 L_sp91
    s_branch L_abort
L_spd91:
L_po92:
    global_load_dwordx4 v[36:39], v25, s[60:61] offset:0 sc1
    global_load_dwordx4 v[48:51], v25, s[60:61] offset:512 sc1
    s_waitcnt vmcnt(0)
    v_bitop3_b32 v1, v36, v39, v7 bitop3:0x7e
    v_bitop3_b32 v2, v48, v51, v7 bitop3:0x7e
    v_or_b32 v1, v1, v2
    v_and_b32 v1, -1, v1
    v_cmp_ne_u32 vcc, 0, v1
    s_nop 0
    s_cbranch_vccz L_pod92
    s_sleep 8
    s_sub_u32 s29, s29, 1
    s_cbranch_scc0 L_po92
    s_branch L_abort
L_pod92:
    v_max_f32 v2, v37, v49
    s_nop 1
    v_max_f32_dpp v2, v2, v2 quad_perm:[1,0,3,2] row_mask:0xf bank_mask:0xf
    s_nop 1
    v_max_f32_dpp v2, v2, v2 quad_perm:[2,3,0,1] row_mask:0xf bank_mask:0xf
    s_nop 1
    v_max_f32_dpp v2, v2, v2 row_ror:8 row_mask:0xf bank_mask:0xf
    v_sub_f32 v44, v37, v2
    v_sub_f32 v45, v49, v2
    v_exp_f32 v44, v44
    v_exp_f32 v45, v45
    v_mul_f32 v2, v44, v38
    v_fmac_f32 v2, v45, v50
    s_nop 1
    v_add_f32_dpp v2, v2, v2 quad_perm:[1,0,3,2] row_mask:0xf bank_mask:0xf
    s_nop 1
    v_add_f32_dpp v2, v2, v2 quad_perm:[2,3,0,1] row_mask:0xf bank_mask:0xf
    s_nop 1
    v_add_f32_dpp v2, v2, v2 row_ror:8 row_mask:0xf bank_mask:0xf
    v_rcp_f32 v2, v2
    s_nop 0
    v_mul_f32 v12, v44, v2
    v_mul_f32 v13, v45, v2
    s_branch L_late
L_hrdy:
    s_mov_b64 exec, 1
    v_mov_b32 v2, 1
    ds_add_u32 v8, v2 offset:1036
    s_mov_b64 exec, -1
L_late:
    s_lshl_b32 s24, s5, 2
    s_add_u32 s24, s24, s32
    s_lshl_b32 s24, s24, 15
    s_add_u32 s35, s24, 0x1000
    s_mul_i32 s25, s5, 56
    s_lshl_b32 s26, s32, 4
    s_add_u32 s25, s25, s26
    s_lshl_b32 s25, s25, 10
    v_lshrrev_b32 v1, 5, v0
    v_lshlrev_b32 v1, 2, v1
    v_bfe_u32 v2, v0, 2, 1
    v_lshl_add_u32 v1, v2, 1, v1
    v_bfe_u32 v2, v0, 4, 1
    v_add_u32 v1, v1, v2
    s_lshl_b32 s26, s5, 10
    s_lshl_b32 s27, s32, 8
    s_add_u32 s26, s26, s27
    s_add_u32 s26, s26, s34
    s_add_u32 s26, s26, 151552
    v_lshl_add_u32 v25, v1, 5, s26
    s_lshr_b32 s26, s25, 10
    v_lshrrev_b32 v1, 4, v0
    v_lshl_add_u32 v1, v1, 2, s26
    v_lshrrev_b32 v2, 6, v1
    v_lshlrev_b32 v24, 12, v2
    v_and_b32 v1, 63, v1
    v_lshl_add_u32 v24, v1, 2, v24
    v_bfe_u32 v1, v0, 3, 1
    v_lshl_add_u32 v24, v1, 11, v24
    v_and_b32 v1, 3, v0
    v_lshl_add_u32 v24, v1, 9, v24
    v_bfe_u32 v1, v0, 2, 1
    v_lshl_add_u32 v24, v1, 8, v24
    v_add_u32 v24, 1474560, v24
    v_bfe_u32 v1, v0, 2, 1
    v_lshl_add_u32 v55, v1, 6, v20
    v_lshrrev_b32 v1, 4, v0
    v_lshl_add_u32 v55, v1, 4, v55
    s_lshl_b32 s26, s4, 5
    s_add_u32 s26, s26, s5
    s_lshl_b32 s26, s26, 7
    s_add_u32 s26, s26, 151552
    v_add_u32 v55, s26, v55
    v_bfe_u32 v1, v0, 4, 1
    v_lshlrev_b32 v9, 2, v1
    v_lshrrev_b32 v1, 5, v0
    v_lshl_add_u32 v9, v1, 1, v9
    s_lshl_b32 s26, s6, 10
    s_lshl_b32 s27, s4, 7
    s_add_u32 s26, s26, s27
    s_and_b32 s27, s5, 15
    s_lshl_b32 s27, s27, 3
    s_add_u32 s26, s26, s27
    v_add_u32 v9, s26, v9
    v_mov_b32 v32, v6
    v_mov_b32 v33, v6
    v_mov_b32 v34, v6
    v_mov_b32 v35, v6
L_sp93:
    ds_read_b32 v2, v8 offset:1036
    s_waitcnt lgkmcnt(0)
    v_readfirstlane_b32 s26, v2
    s_nop 0
    s_cmp_eq_u32 s26, 1
    s_cbranch_scc1 L_spd93
    s_sleep 4
    s_sub_u32 s29, s29, 1
    s_cbranch_scc0 L_sp93
    s_branch L_abort
L_spd93:
    v_lshlrev_b32 v2, 3, v0
    ds_read_b64 v[10:11], v2 offset:3072
L_sp94:
    ds_read_b32 v2, v8 offset:1032
    s_waitcnt lgkmcnt(0)
    v_readfirstlane_b32 s26, v2
    s_nop 0
    s_cmp_ge_u32 s26, 122
    s_cbranch_scc1 L_spd94
    s_sleep 2
    s_sub_u32 s29, s29, 1
    s_cbranch_scc0 L_sp94
    s_branch L_abort
L_spd94:
    s_mov_b32 s96, -1
    s_cmp_eq_u32 s32, 3
    s_cselect_b32 s97, 0, -1
L_po95:
    s_mov_b64 exec, s[96:97]
    global_load_dwordx4 v[32:35], v24, s[60:61] offset:0 sc1
    s_mov_b64 exec, -1
    s_waitcnt vmcnt(0)
    v_bitop3_b32 v1, v32, v33, v7 bitop3:0x7e
    v_bitop3_b32 v2, v34, v35, v7 bitop3:0x7e
    v_or_b32 v1, v1, v2
    v_and_b32 v1, 0x3ff, v1
    v_cmp_ne_u32 vcc, 0, v1
    s_nop 0
    s_cbranch_vccz L_pod95
    s_sleep 8
    s_sub_u32 s29, s29, 1
    s_cbranch_scc0 L_po95
    s_branch L_abort
L_pod95:
    v_and_b32 v32, s91, v32
    v_and_b32 v33, s91, v33
    v_and_b32 v34, s91, v34
    v_and_b32 v35, s91, v35
    v_add_f32_dpp v32, v32, v32 quad_perm:[1,0,3,2] row_mask:0xf bank_mask:0xf
    v_add_f32_dpp v33, v33, v33 quad_perm:[1,0,3,2] row_mask:0xf bank_mask:0xf
    v_add_f32_dpp v34, v34, v34 quad_perm:[1,0,3,2] row_mask:0xf bank_mask:0xf
    v_add_f32_dpp v35, v35, v35 quad_perm:[1,0,3,2] row_mask:0xf bank_mask:0xf
    v_add_f32_dpp v32, v32, v32 quad_perm:[2,3,0,1] row_mask:0xf bank_mask:0xf
    v_add_f32_dpp v33, v33, v33 quad_perm:[2,3,0,1] row_mask:0xf bank_mask:0xf
    v_add_f32_dpp v34, v34, v34 quad_perm:[2,3,0,1] row_mask:0xf bank_mask:0xf
    v_add_f32_dpp v35, v35, v35 quad_perm:[2,3,0,1] row_mask:0xf bank_mask:0xf
    v_cvt_pk_bf16_f32 v28, v32, v33
    v_cvt_pk_bf16_f32 v29, v34, v35
    v_lshlrev_b32 v32, 16, v28
    v_and_b32 v33, s90, v28
    v_lshlrev_b32 v34, 16, v29
    v_and_b32 v35, s90, v29
    v_mov_b32_dpp v36, v32 row_ror:8 row_mask:0xf bank_mask:0xf
    v_mov_b32_dpp v37, v33 row_ror:8 row_mask:0xf bank_mask:0xf
    v_mov_b32_dpp v38, v34 row_ror:8 row_mask:0xf bank_mask:0xf
    v_mov_b32_dpp v39, v35 row_ror:8 row_mask:0xf bank_mask:0xf
    v_mul_f32 v32, s89, v32
    v_mul_f32 v33, s89, v33
    v_mul_f32 v34, s89, v34
    v_mul_f32 v35, s89, v35
    v_exp_f32 v32, -v32
    v_exp_f32 v33, -v33
    v_exp_f32 v34, -v34
    v_exp_f32 v35, -v35
    v_add_f32 v32, 1.0, v32
    v_add_f32 v33, 1.0, v33
    v_add_f32 v34, 1.0, v34
    v_add_f32 v35, 1.0, v35
    v_rcp_f32 v32, v32
    v_rcp_f32 v33, v33
    v_rcp_f32 v34, v34
    v_rcp_f32 v35, v35
    v_cvt_pk_bf16_f32 v28, v32, v33
    v_cvt_pk_bf16_f32 v29, v34, v35
    v_lshlrev_b32 v32, 16, v28
    v_and_b32 v33, s90, v28
    v_lshlrev_b32 v34, 16, v29
    v_and_b32 v35, s90, v29
    v_mul_f32 v32, v32, v36
    v_mul_f32 v33, v33, v37
    v_mul_f32 v34, v34, v38
    v_mul_f32 v35, v35, v39
    v_cvt_pk_bf16_f32 v46, v32, v33
    v_cvt_pk_bf16_f32 v47, v34, v35
    s_cmp_lg_u32 s32, 0
    s_cbranch_scc1 L_wait1
    global_load_dwordx4 v[64:67], v14, s[60:61] offset:0 sc1
    global_load_dwordx4 v[68:71], v14, s[60:61] offset:1024 sc1
    global_load_dwordx4 v[72:75], v21, s[60:61] offset:0 sc1
    global_load_dwordx4 v[76:79], v21, s[60:61] offset:1024 sc1
    global_load_ushort v40, v9, s[56:57]
L_sp96:
    ds_read_b32 v2, v8 offset:1028
    s_waitcnt lgkmcnt(0)
    v_readfirstlane_b32 s26, v2
    s_nop 0
    s_cmp_eq_u32 s26, 4
    s_cbranch_scc1 L_spd96
    s_sleep 1
    s_sub_u32 s29, s29, 1
    s_cbranch_scc0 L_sp96
    s_branch L_abort
L_spd96:
    v_mov_b32 v37, 1
L_po97:
    global_load_dwordx4 v[64:67], v14, s[60:61] offset:0 sc1
    global_load_dwordx4 v[68:71], v14, s[60:61] offset:1024 sc1
    s_waitcnt vmcnt(0)
    v_bitop3_b32 v1, v64, v65, v7 bitop3:0x7e
    v_bitop3_b32 v2, v66, v67, v7 bitop3:0x7e
    v_bitop3_b32 v3, v68, v69, v7 bitop3:0x7e
    v_bitop3_b32 v4, v70, v71, v7 bitop3:0x7e
    v_or3_b32 v1, v1, v2, v3
    v_or_b32 v4, v4, v1
    v_and_b32 v4, 0x3ff, v4
    v_cmp_ne_u32 vcc, 0, v4
    s_nop 0
    s_cbranch_vccz L_pod97
    s_sub_u32 s29, s29, 1
    s_cbranch_scc0 L_po97
    s_branch L_abort
L_pod97:
    ds_write_b32 v8, v37 offset:1052
    v_and_b32 v64, s91, v64
    v_and_b32 v65, s91, v65
    v_and_b32 v66, s91, v66
    v_and_b32 v67, s91, v67
    v_and_b32 v68, s91, v68
    v_and_b32 v69, s91, v69
    v_and_b32 v70, s91, v70
    v_and_b32 v71, s91, v71
    v_pk_mul_f32 v[64:65], v[64:65], v[12:13] op_sel_hi:[1,0]
    v_pk_mul_f32 v[66:67], v[66:67], v[12:13] op_sel_hi:[1,0]
    v_pk_fma_f32 v[64:65], v[68:69], v[12:13], v[64:65] op_sel:[0,1,0] op_sel_hi:[1,1,1]
    v_pk_fma_f32 v[66:67], v[70:71], v[12:13], v[66:67] op_sel:[0,1,0] op_sel_hi:[1,1,1]
    s_nop 0
    v_add_f32_dpp v64, v64, v64 quad_perm:[1,0,3,2] row_mask:0xf bank_mask:0xf
    v_add_f32_dpp v65, v65, v65 quad_perm:[1,0,3,2] row_mask:0xf bank_mask:0xf
    v_add_f32_dpp v66, v66, v66 quad_perm:[1,0,3,2] row_mask:0xf bank_mask:0xf
    v_add_f32_dpp v67, v67, v67 quad_perm:[1,0,3,2] row_mask:0xf bank_mask:0xf
    v_add_f32_dpp v64, v64, v64 quad_perm:[2,3,0,1] row_mask:0xf bank_mask:0xf
    v_add_f32_dpp v65, v65, v65 quad_perm:[2,3,0,1] row_mask:0xf bank_mask:0xf
    v_add_f32_dpp v66, v66, v66 quad_perm:[2,3,0,1] row_mask:0xf bank_mask:0xf
    v_add_f32_dpp v67, v67, v67 quad_perm:[2,3,0,1] row_mask:0xf bank_mask:0xf
    v_add_f32_dpp v64, v64, v64 row_ror:8 row_mask:0xf bank_mask:0xf
    v_add_f32_dpp v65, v65, v65 row_ror:8 row_mask:0xf bank_mask:0xf
    v_add_f32_dpp v66, v66, v66 row_ror:8 row_mask:0xf bank_mask:0xf
    v_add_f32_dpp v67, v67, v67 row_ror:8 row_mask:0xf bank_mask:0xf
    v_cvt_pk_bf16_f32 v28, v64, v65
    v_cvt_pk_bf16_f32 v29, v66, v67
    v_lshl_or_b32 v40, v28, 16, v22
    v_and_or_b32 v41, v28, s90, v22
    v_lshl_or_b32 v42, v29, 16, v22
    v_and_or_b32 v43, v29, s90, v22
    global_store_dwordx4 v55, v[40:43], s[60:61] sc1
    s_branch L_go1
L_wait1:
L_sp98:
    ds_read_b32 v2, v8 offset:1052
    s_waitcnt lgkmcnt(0)
    v_readfirstlane_b32 s26, v2
    s_nop 0
    s_cmp_eq_u32 s26, 1
    s_cbranch_scc1 L_spd98
    s_sub_u32 s29, s29, 1
    s_cbranch_scc0 L_sp98
    s_branch L_abort
L_spd98:
L_go1:
    s_mov_b64 exec, s[96:97]
    buffer_load_dwordx2 v[96:97], v54, s[20:23], s25 offen offset:0 nt
    buffer_load_dwordx2 v[98:99], v54, s[20:23], s25 offen offset:1024 nt
    buffer_load_dwordx2 v[100:101], v54, s[20:23], s25 offen offset:2048 nt
    buffer_load_dwordx2 v[102:103], v54, s[20:23], s25 offen offset:3072 nt
    s_mov_b64 exec, -1
    buffer_load_dwordx2 v[128:129], v23, s[16:19], s24 offen offset:0 nt
    buffer_load_dwordx2 v[130:131], v23, s[16:19], s24 offen offset:1024 nt
    buffer_load_dwordx2 v[132:133], v23, s[16:19], s24 offen offset:2048 nt
    buffer_load_dwordx2 v[134:135], v23, s[16:19], s24 offen offset:3072 nt
    buffer_load_dwordx2 v[136:137], v23, s[16:19], s35 offen offset:0 nt
    buffer_load_dwordx2 v[138:139], v23, s[16:19], s35 offen offset:1024 nt
    buffer_load_dwordx2 v[140:141], v23, s[16:19], s35 offen offset:2048 nt
    buffer_load_dwordx2 v[142:143], v23, s[16:19], s35 offen offset:3072 nt
L_go2:
    global_load_dwordx4 v[160:163], v25, s[60:61] offset:0 sc1
    global_load_dwordx4 v[164:167], v25, s[60:61] offset:16 sc1
    s_waitcnt vmcnt(10)
    v_perm_b32 v112, v98, v96, s30
    v_perm_b32 v113, v102, v100, s30
    v_perm_b32 v114, v98, v96, s31
    v_perm_b32 v115, v102, v100, s31
    v_perm_b32 v116, v99, v97, s30
    v_perm_b32 v117, v103, v101, s30
    v_perm_b32 v118, v99, v97, s31
    v_perm_b32 v119, v103, v101, s31
    v_mfma_f32_16x16x16_bf16 v[228:231], v[46:47], v[112:113], 0
    v_mfma_f32_16x16x16_bf16 v[232:235], v[46:47], v[114:115], 0
    v_mfma_f32_16x16x16_bf16 v[236:239], v[46:47], v[116:117], 0
    v_mfma_f32_16x16x16_bf16 v[240:243], v[46:47], v[118:119], 0
    s_waitcnt vmcnt(8)
    v_perm_b32 v144, v130, v128, s30
    v_perm_b32 v148, v130, v128, s31
    v_perm_b32 v152, v131, v129, s30
    v_perm_b32 v156, v131, v129, s31
    s_waitcnt vmcnt(6)
    v_perm_b32 v145, v134, v132, s30
    v_perm_b32 v149, v134, v132, s31
    v_perm_b32 v153, v135, v133, s30
    v_perm_b32 v157, v135, v133, s31
    v_mul_f32 v16, v11, v228
    v_mul_f32 v17, v11, v232
    v_mul_f32 v18, v11, v236
    v_mul_f32 v19, v11, v240
    s_waitcnt vmcnt(4)
    v_perm_b32 v146, v138, v136, s30
    v_perm_b32 v150, v138, v136, s31
    v_perm_b32 v154, v139, v137, s30
    v_perm_b32 v158, v139, v137, s31
    s_waitcnt vmcnt(2)
    v_perm_b32 v147, v142, v140, s30
    v_perm_b32 v151, v142, v140, s31
    v_perm_b32 v155, v143, v141, s30
    v_perm_b32 v159, v143, v141, s31
L_got2:
    s_waitcnt vmcnt(0)
    v_perm_b32 v224, v161, v160, s31
    v_perm_b32 v225, v163, v162, s31
    v_perm_b32 v226, v165, v164, s31
    v_perm_b32 v227, v167, v166, s31
    s_nop 1
    v_mfma_f32_16x16x32_bf16 v[228:231], v[224:227], v[144:147], 0
    v_mfma_f32_16x16x32_bf16 v[232:235], v[224:227], v[148:151], 0
    v_mfma_f32_16x16x32_bf16 v[236:239], v[224:227], v[152:155], 0
    v_mfma_f32_16x16x32_bf16 v[240:243], v[224:227], v[156:159], 0
    v_bitop3_b32 v1, v160, v161, v7 bitop3:0x7e
    v_bitop3_b32 v2, v162, v163, v7 bitop3:0x7e
    v_bitop3_b32 v3, v164, v165, v7 bitop3:0x7e
    v_bitop3_b32 v4, v166, v167, v7 bitop3:0x7e
    v_or3_b32 v1, v1, v2, v3
    v_or_b32 v4, v4, v1
    v_and_b32 v4, 0xffff, v4
    v_cmp_ne_u32 vcc, 0, v4
    s_nop 0
    s_cbranch_vccnz L_retry2
    s_mov_b32 exec_hi, 0
    v_fma_f32 v16, v10, v228, v16
    v_fma_f32 v17, v10, v232, v17
    v_fma_f32 v18, v10, v236, v18
    v_fma_f32 v19, v10, v240, v19
    v_and_or_b32 v16, v16, s91, v6
    v_and_or_b32 v17, v17, s91, v6
    v_and_or_b32 v18, v18, s91, v6
    v_and_or_b32 v19, v19, s91, v6
    s_cmp_eq_u32 s94, 2
    s_cbranch_scc0 L_pubs99
    global_store_dwordx4 v15, v[16:19], s[60:61]
L_pubd99:
    s_mov_b64 exec, -1
    s_cmp_lg_u32 s32, 0
    s_cbranch_scc1 L_hdone
L_fin:
    global_load_dwordx4 v[160:163], v21, s[60:61] offset:0 sc1
    global_load_dwordx4 v[164:167], v21, s[60:61] offset:1024 sc1
    s_waitcnt vmcnt(0)
    v_bitop3_b32 v1, v160, v161, v7 bitop3:0x7e
    v_bitop3_b32 v2, v162, v163, v7 bitop3:0x7e
    v_bitop3_b32 v3, v164, v165, v7 bitop3:0x7e
    v_bitop3_b32 v4, v166, v167, v7 bitop3:0x7e
    v_or3_b32 v1, v1, v2, v3
    v_or_b32 v1, v1, v4
    v_and_b32 v1, 0x3ff, v1
    v_cmp_ne_u32 vcc, 0, v1
    v_and_b32 v160, s91, v160
    s_cbranch_vccnz L_retry3
    v_and_b32 v161, s91, v161
    v_and_b32 v162, s91, v162
    v_and_b32 v163, s91, v163
    v_and_b32 v164, s91, v164
    v_and_b32 v165, s91, v165
    v_and_b32 v166, s91, v166
    v_and_b32 v167, s91, v167
    v_pk_add_f32 v[160:161], v[160:161], v[164:165]
    v_pk_add_f32 v[162:163], v[162:163], v[166:167]
    s_nop 0
    v_permlane32_swap_b32 v160, v161
    v_permlane32_swap_b32 v162, v163
    v_add_f32 v160, v160, v161
    v_add_f32 v162, v162, v163
    s_nop 1
    v_permlane16_swap_b32 v160, v162
    v_add_f32 v160, v160, v162
    s_nop 1
    v_add_f32_dpp v160, v160, v160 row_ror:8 row_mask:0xf bank_mask:0xf
    s_nop 1
    v_add_f32_dpp v160, v160, v160 row_ror:4 row_mask:0xf bank_mask:0xf
    s_nop 1
    v_add_f32_dpp v160, v160, v160 quad_perm:[1,0,3,2] row_mask:0xf bank_mask:0xf
    s_nop 1
    v_add_f32_dpp v160, v160, v160 quad_perm:[2,3,0,1] row_mask:0xf bank_mask:0xf
    v_cvt_pk_bf16_f32 v160, v160, v160
    s_mov_b32 exec_lo, 0x00010001
    s_mov_b32 exec_hi, 0x00010001
    global_store_short v9, v160, s[56:57]
    s_cmp_lg_u32 s2, 0
    s_cbranch_scc1 L_noep
    s_mov_b64 exec, 1
    v_mov_b32 v1, 149504
    global_store_dword v1, v7, s[60:61]
L_noep:
L_hdone:
    s_endpgm
L_retry3:
    s_sub_u32 s29, s29, 1
    s_cbranch_scc0 L_fin
    s_branch L_abort
L_retry2:
    global_load_dwordx4 v[160:163], v25, s[60:61] offset:0 sc1
    global_load_dwordx4 v[164:167], v25, s[60:61] offset:16 sc1
    s_sub_u32 s29, s29, 1
    s_cbranch_scc0 L_got2
    s_branch L_abort
L_pubs81:
    global_store_dwordx4 v1, v[8:11], s[60:61] offset:0 sc1
    s_branch L_pubd81
L_pubs82:
    global_store_dwordx4 v1, v[12:15], s[60:61] offset:256 sc1
    s_branch L_pubd82
L_qslow:
    s_mov_b32 s94, 1
    s_mov_b32 exec_hi, 0
    v_and_or_b32 v16, v16, s92, v22
    v_and_or_b32 v17, v17, s92, v22
    v_and_or_b32 v18, v18, s92, v22
    v_and_or_b32 v19, v19, s92, v22
    global_store_dwordx4 v21, v[16:19], s[60:61] sc1
    s_mov_b64 exec, -1
L_po100:
    global_load_dwordx4 v[160:163], v14, s[60:61] offset:-4096 sc1
    global_load_dwordx4 v[164:167], v14, s[60:61] offset:0 sc1
    global_load_dwordx4 v[168:171], v15, s[60:61] offset:-4096 sc1
    global_load_dwordx4 v[172:175], v15, s[60:61] offset:0 sc1
    global_load_dwordx4 v[176:179], v14, s[60:61] offset:-3968 sc1
    global_load_dwordx4 v[180:183], v14, s[60:61] offset:128 sc1
    global_load_dwordx4 v[184:187], v15, s[60:61] offset:-3968 sc1
    global_load_dwordx4 v[188:191], v15, s[60:61] offset:128 sc1
    s_waitcnt vmcnt(0)
    v_mov_b32 v3, 0
    v_sub_u32 v1, v160, v6
    v_and_b32 v1, 0xff, v1
    v_subrev_u32 v2, s33, v1
    v_mul_i32_i24 v1, v1, v2
    v_or_b32 v3, v3, v1
    v_sub_u32 v1, v161, v6
    v_and_b32 v1, 0xff, v1
    v_subrev_u32 v2, s33, v1
    v_mul_i32_i24 v1, v1, v2
    v_or_b32 v3, v3, v1
    v_sub_u32 v1, v162, v6
    v_and_b32 v1, 0xff, v1
    v_subrev_u32 v2, s33, v1
    v_mul_i32_i24 v1, v1, v2
    v_or_b32 v3, v3, v1
    v_sub_u32 v1, v163, v6
    v_and_b32 v1, 0xff, v1
    v_subrev_u32 v2, s33, v1
    v_mul_i32_i24 v1, v1, v2
    v_or_b32 v3, v3, v1
    v_sub_u32 v1, v164, v6
    v_and_b32 v1, 0xff, v1
    v_subrev_u32 v2, s33, v1
    v_mul_i32_i24 v1, v1, v2
    v_or_b32 v3, v3, v1
    v_sub_u32 v1, v165, v6
    v_and_b32 v1, 0xff, v1
    v_subrev_u32 v2, s33, v1
    v_mul_i32_i24 v1, v1, v2
    v_or_b32 v3, v3, v1
    v_sub_u32 v1, v166, v6
    v_and_b32 v1, 0xff, v1
    v_subrev_u32 v2, s33, v1
    v_mul_i32_i24 v1, v1, v2
    v_or_b32 v3, v3, v1
    v_sub_u32 v1, v167, v6
    v_and_b32 v1, 0xff, v1
    v_subrev_u32 v2, s33, v1
    v_mul_i32_i24 v1, v1, v2
    v_or_b32 v3, v3, v1
    v_sub_u32 v1, v168, v6
    v_and_b32 v1, 0xff, v1
    v_subrev_u32 v2, s33, v1
    v_mul_i32_i24 v1, v1, v2
    v_or_b32 v3, v3, v1
    v_sub_u32 v1, v169, v6
    v_and_b32 v1, 0xff, v1
    v_subrev_u32 v2, s33, v1
    v_mul_i32_i24 v1, v1, v2
    v_or_b32 v3, v3, v1
    v_sub_u32 v1, v170, v6
    v_and_b32 v1, 0xff, v1
    v_subrev_u32 v2, s33, v1
    v_mul_i32_i24 v1, v1, v2
    v_or_b32 v3, v3, v1
    v_sub_u32 v1, v171, v6
    v_and_b32 v1, 0xff, v1
    v_subrev_u32 v2, s33, v1
    v_mul_i32_i24 v1, v1, v2
    v_or_b32 v3, v3, v1
    v_sub_u32 v1, v172, v6
    v_and_b32 v1, 0xff, v1
    v_subrev_u32 v2, s33, v1
    v_mul_i32_i24 v1, v1, v2
    v_or_b32 v3, v3, v1
    v_sub_u32 v1, v173, v6
    v_and_b32 v1, 0xff, v1
    v_subrev_u32 v2, s33, v1
    v_mul_i32_i24 v1, v1, v2
    v_or_b32 v3, v3, v1
    v_sub_u32 v1, v174, v6
    v_and_b32 v1, 0xff, v1
    v_subrev_u32 v2, s33, v1
    v_mul_i32_i24 v1, v1, v2
    v_or_b32 v3, v3, v1
    v_sub_u32 v1, v175, v6
    v_and_b32 v1, 0xff, v1
    v_subrev_u32 v2, s33, v1
    v_mul_i32_i24 v1, v1, v2
    v_or_b32 v3, v3, v1
    v_sub_u32 v1, v176, v6
    v_and_b32 v1, 0xff, v1
    v_subrev_u32 v2, s33, v1
    v_mul_i32_i24 v1, v1, v2
    v_or_b32 v3, v3, v1
    v_sub_u32 v1, v177, v6
    v_and_b32 v1, 0xff, v1
    v_subrev_u32 v2, s33, v1
    v_mul_i32_i24 v1, v1, v2
    v_or_b32 v3, v3, v1
    v_sub_u32 v1, v178, v6
    v_and_b32 v1, 0xff, v1
    v_subrev_u32 v2, s33, v1
    v_mul_i32_i24 v1, v1, v2
    v_or_b32 v3, v3, v1
    v_sub_u32 v1, v179, v6
    v_and_b32 v1, 0xff, v1
    v_subrev_u32 v2, s33, v1
    v_mul_i32_i24 v1, v1, v2
    v_or_b32 v3, v3, v1
    v_sub_u32 v1, v180, v6
    v_and_b32 v1, 0xff, v1
    v_subrev_u32 v2, s33, v1
    v_mul_i32_i24 v1, v1, v2
    v_or_b32 v3, v3, v1
    v_sub_u32 v1, v181, v6
    v_and_b32 v1, 0xff, v1
    v_subrev_u32 v2, s33, v1
    v_mul_i32_i24 v1, v1, v2
    v_or_b32 v3, v3, v1
    v_sub_u32 v1, v182, v6
    v_and_b32 v1, 0xff, v1
    v_subrev_u32 v2, s33, v1
    v_mul_i32_i24 v1, v1, v2
    v_or_b32 v3, v3, v1
    v_sub_u32 v1, v183, v6
    v_and_b32 v1, 0xff, v1
    v_subrev_u32 v2, s33, v1
    v_mul_i32_i24 v1, v1, v2
    v_or_b32 v3, v3, v1
    v_sub_u32 v1, v184, v6
    v_and_b32 v1, 0xff, v1
    v_subrev_u32 v2, s33, v1
    v_mul_i32_i24 v1, v1, v2
    v_or_b32 v3, v3, v1
    v_sub_u32 v1, v185, v6
    v_and_b32 v1, 0xff, v1
    v_subrev_u32 v2, s33, v1
    v_mul_i32_i24 v1, v1, v2
    v_or_b32 v3, v3, v1
    v_sub_u32 v1, v186, v6
    v_and_b32 v1, 0xff, v1
    v_subrev_u32 v2, s33, v1
    v_mul_i32_i24 v1, v1, v2
    v_or_b32 v3, v3, v1
    v_sub_u32 v1, v187, v6
    v_and_b32 v1, 0xff, v1
    v_subrev_u32 v2, s33, v1
    v_mul_i32_i24 v1, v1, v2
    v_or_b32 v3, v3, v1
    v_sub_u32 v1, v188, v6
    v_and_b32 v1, 0xff, v1
    v_subrev_u32 v2, s33, v1
    v_mul_i32_i24 v1, v1, v2
    v_or_b32 v3, v3, v1
    v_sub_u32 v1, v189, v6
    v_and_b32 v1, 0xff, v1
    v_subrev_u32 v2, s33, v1
    v_mul_i32_i24 v1, v1, v2
    v_or_b32 v3, v3, v1
    v_sub_u32 v1, v190, v6
    v_and_b32 v1, 0xff, v1
    v_subrev_u32 v2, s33, v1
    v_mul_i32_i24 v1, v1, v2
    v_or_b32 v3, v3, v1
    v_sub_u32 v1, v191, v6
    v_and_b32 v1, 0xff, v1
    v_subrev_u32 v2, s33, v1
    v_mul_i32_i24 v1, v1, v2
    v_or_b32 v3, v3, v1
    v_cmp_ne_u32 vcc, 0, v3
    s_nop 0
    s_cbranch_vccz L_pod100
    s_sleep 4
    s_sub_u32 s29, s29, 1
    s_cbranch_scc0 L_po100
    s_branch L_abort
L_pod100:
    s_branch L_qok
L_pubs90:
    global_store_dwordx4 v1, v[40:43], s[60:61] sc1
    s_branch L_pubd90
L_pubs99:
    global_store_dwordx4 v15, v[16:19], s[60:61] sc1
    s_branch L_pubd99
L_abort:
    s_mov_b64 exec, 1
    v_mov_b32 v1, 8
    v_mov_b32 v2, 0xdead
    global_store_dword v1, v2, s[58:59]
L_end:
    s_endpgm
.section .rodata,"a"
.p2align 6
.amdhsa_kernel gated_mix__gqa_block_cached__glu_gated_glu__decode_kernel
  .amdhsa_next_free_vgpr 256
  .amdhsa_next_free_sgpr 102
  .amdhsa_accum_offset 256
  .amdhsa_group_segment_fixed_size 0
  .amdhsa_kernarg_size 104
  .amdhsa_user_sgpr_count 2
  .amdhsa_user_sgpr_kernarg_segment_ptr 1
  .amdhsa_system_sgpr_workgroup_id_x 1
.end_amdhsa_kernel
```
